```python
import torch

def _softmax(x, axis=-1):
    return torch.softmax(x, dim=axis)
def _gelu(x):
    return torch.nn.functional.gelu(x, approximate="tanh")
def _silu(x):
    return torch.nn.functional.silu(x)
def _sigmoid(x):
    return torch.sigmoid(x)
def _layernorm(x, axis=-1, eps=1e-5):
    m = x.mean(dim=axis, keepdim=True)
    v = x.var(dim=axis, keepdim=True, unbiased=False)
    return (x - m) / torch.sqrt(v + eps)
def _scatter_add(tgt, idx, src, axis=0):
    return tgt.clone().index_add_(axis, idx, src)
def _segment_sum(src, seg, n):
    out = torch.zeros((n,) + src.shape[1:], dtype=src.dtype)
    return out.index_add_(0, seg, src)
def _pad(x, pw):
    flat = tuple(v for pair in reversed(pw) for v in pair)
    return torch.nn.functional.pad(x, flat)

kernel_name = 'gated_mix__mha_block__sliding_local_dilated__prompt'

def setup_inputs():

    _w = (lambda a: (lambda t: t.to(torch.bfloat16) if t.is_floating_point() else t)(torch.as_tensor(a)))
    def _A_setup():
        B, S, D, H = 1, 2048, 448, 16
        return {
            "x": _w((lambda *s: torch.randn(*s, dtype=torch.bfloat16) * 0.05)(B, S, D)),
            "wqkv": _w((lambda *s: torch.randn(*s, dtype=torch.bfloat16) * 1.6)(D, 3 * D)),
            "wo": _w((lambda *s: torch.randn(*s, dtype=torch.bfloat16) * 0.1)(D, D)),
        }
    _A_in = _A_setup()

    def _B_setup():
        B, S, D = 1, 2048, 448
        return {
            "x": _w((lambda *s: torch.randn(*s, dtype=torch.bfloat16) * 0.05)(B, S, D)),
            "wqkv": _w((lambda *s: torch.randn(*s, dtype=torch.bfloat16) * 1.6)(D, 3 * D)),
            "wo": _w((lambda *s: torch.randn(*s, dtype=torch.bfloat16) * 0.05)(D, D)),
        }
    _B_in = _B_setup()

    return {
        "A_x": _A_in["x"],
        "A_wqkv": _A_in["wqkv"],
        "A_wo": _A_in["wo"],
        "B_x": _B_in["x"],
        "B_wqkv": _B_in["wqkv"],
        "B_wo": _B_in["wo"],
        "gate_w": _w((lambda *s: torch.randn(*s, dtype=torch.bfloat16) * 0.05)(448) * 16.0),
    }

def reference(A_x, A_wqkv, A_wo, B_x, B_wqkv, B_wo, gate_w):
    def _A_ref(x, wqkv, wo):
        B, S, D = x.shape
        H = 16
        Dh = D // H
        qkv = (lambda x, *d: x.permute(*d))((x @ wqkv).reshape(B, S, 3, H, Dh), 2, 0, 3, 1, 4)
        q, k, v = qkv[0], qkv[1], qkv[2]
        scores = torch.einsum("bhqd,bhkd->bhqk", q, k) * (Dh ** -0.5)
        p = _softmax(scores, axis=-1)
        o = torch.einsum("bhqk,bhkd->bhqd", p, v)
        return (lambda x, *d: x.permute(*d))(o, 0, 2, 1, 3).reshape(B, S, D) @ wo

    def _B_ref(x, wqkv, wo):
        B, S, D = x.shape
        H = 16; Dh = D // H
        W, dil = 8, 2
        qkv = (lambda x, *d: x.permute(*d))((x @ wqkv).reshape(B, S, 3, H, Dh), 2, 0, 3, 1, 4)
        q, k, v = qkv[0], qkv[1], qkv[2]
        scale = Dh ** -0.5
        pos = torch.arange(S)
        off = torch.arange(W) * dil
        idx = pos[:, None] - off[None, :]
        mask = idx >= 0
        idx_c = torch.where(mask, idx, 0).reshape(-1)
        kg = k[:, :, idx_c, :].reshape(B, H, S, W, Dh)
        vg = v[:, :, idx_c, :].reshape(B, H, S, W, Dh)
        logits = torch.einsum("bhsd,bhswd->bhsw", q, kg) * scale
        logits = torch.where(mask[None, None, :, :], logits, -1e9)
        attn = _softmax(logits, axis=-1)
        o = torch.einsum("bhsw,bhswd->bhsd", attn, vg)
        return (lambda x, *d: x.permute(*d))(o, 0, 2, 1, 3).reshape(B, S, D) @ wo

    x = A_x
    g = _sigmoid((x * gate_w).sum(-1, keepdims=True))
    a = _A_ref(x, A_wqkv, A_wo)
    b = _B_ref(x, B_wqkv, B_wo)
    return g * a + (1 - g) * b
```

```asm
; @launch grid=(256,1,1) block=(512,1,1) lds=163840
.amdgcn_target "amdgcn-amd-amdhsa--gfx950"
.text
.globl gated_mix__mha_block__sliding_local_dilated__prompt_kernel
.p2align 8
.type gated_mix__mha_block__sliding_local_dilated__prompt_kernel,@function
gated_mix__mha_block__sliding_local_dilated__prompt_kernel:
    s_cmp_ge_u32 s2, 256
    s_cbranch_scc1 K_END
    s_load_dwordx16 s[68:83], s[0:1], 0
    s_load_dwordx4 s[84:87], s[0:1], 64
    v_lshrrev_b32 v1, 6, v0
    v_and_b32 v0, 63, v0
    v_readfirstlane_b32 s40, v1
    s_and_b32 s41, s2, 7
    s_lshr_b32 s42, s2, 3
    v_lshlrev_b32 v1, 4, v0
    s_getpc_b64 s[52:53]
PCREF:
    s_sub_u32 s52, s52, PCREF-gated_mix__mha_block__sliding_local_dilated__prompt_kernel
    s_subb_u32 s53, s53, 0
    s_and_b32 s53, s53, 0xffff
    s_mov_b32 s54, K_CODE_END-gated_mix__mha_block__sliding_local_dilated__prompt_kernel
    s_mov_b32 s55, 0x20000
    s_lshl_b32 s50, s42, 2
    s_add_u32 s50, s50, s40
    s_lshl_b32 s50, s50, 10
    s_cmp_ge_u32 s40, 4
    s_cbranch_scc1 NOPF
    buffer_load_dwordx4 v[240:243], v1, s[52:55], s50 offen
NOPF:
    s_lshr_b32 s50, s41, 1
    s_lshl_b32 s50, s50, 3
    s_and_b32 s51, s41, 1
    s_and_b32 s43, s42, 7
    s_add_u32 s43, s43, s50
    s_lshr_b32 s44, s42, 3
    s_lshl_b32 s61, s51, 2
    s_add_u32 s44, s44, s61
    s_sub_u32 s62, s42, 24
    s_add_u32 s62, s62, s61
    s_add_u32 s62, s62, s50
    s_cmp_ge_u32 s42, 24
    s_cselect_b32 s43, s62, s43
    s_cselect_b32 s44, 3, s44
    s_lshl_b32 s3, s41, 2
    s_add_u32 s3, s3, s42
    s_sub_u32 s3, s3, 28
    s_cmp_ge_u32 s42, 28
    s_cselect_b32 s3, s3, -1
    s_cmp_lt_u32 s40, 4
    s_cbranch_scc1 COMPUTE
    s_cmp_lg_u32 s3, -1
    s_cbranch_scc1 GATE_H
HELPER:
    s_setprio 1
    s_sub_u32 s56, s40, 4
    v_lshrrev_b32 v2, 3, v0
    v_and_b32 v3, 7, v0
    v_lshrrev_b32 v4, 4, v0
    v_xor_b32 v8, v3, v4
    v_lshlrev_b32 v8, 4, v8
    s_movk_i32 s50, 896
    v_mad_u32_u24 v5, v2, s50, v8
    v_xor_b32 v6, 64, v5
    v_and_b32 v4, 1, v4
    v_lshlrev_b32 v4, 2, v4
    v_xor_b32 v8, v3, v4
    v_lshlrev_b32 v8, 4, v8
    s_movk_i32 s50, 2688
    v_mad_u32_u24 v7, v2, s50, v8
    s_lshl_b32 s57, s43, 6
    s_lshl_b32 s50, s56, 4
    s_add_u32 s57, s57, s50
    s_mul_i32 s57, s57, 896
    s_lshl_b32 s58, s44, 7
    s_mul_i32 s50, s56, 43008
    s_add_u32 s58, s58, s50
    s_lshl_b32 s59, s56, 11
    s_waitcnt lgkmcnt(0)
    s_mov_b32 s4, s68
    s_and_b32 s5, s69, 0xffff
    s_mov_b32 s6, 1835008
    s_mov_b32 s7, 0x20000
    s_mov_b32 s8, s70
    s_and_b32 s9, s71, 0xffff
    s_mov_b32 s10, 1204224
    s_mov_b32 s11, 0x20000
    s_add_u32 s50, s57, 0
    s_add_u32 m0, s59, 0
    s_nop 0
    buffer_load_dwordx4 v5, s[4:7], s50 offen lds
    s_add_u32 s50, s57, 7168
    s_add_u32 m0, s59, 1024
    s_nop 0
    buffer_load_dwordx4 v6, s[4:7], s50 offen lds
    s_add_u32 s50, s58, 896
    s_add_u32 m0, s59, 57344
    s_nop 0
    buffer_load_dwordx4 v7, s[8:11], s50 offen lds
    s_add_u32 s50, s58, 22400
    s_add_u32 m0, s59, 58368
    s_nop 0
    buffer_load_dwordx4 v7, s[8:11], s50 offen lds
    s_add_u32 s50, s58, 1792
    s_add_u32 m0, s59, 65536
    s_nop 0
    buffer_load_dwordx4 v7, s[8:11], s50 offen lds
    s_add_u32 s50, s58, 23296
    s_add_u32 m0, s59, 66560
    s_nop 0
    buffer_load_dwordx4 v7, s[8:11], s50 offen lds
    s_add_u32 s50, s57, 128
    s_add_u32 m0, s59, 8192
    s_nop 0
    buffer_load_dwordx4 v5, s[4:7], s50 offen lds
    s_add_u32 s50, s57, 7296
    s_add_u32 m0, s59, 9216
    s_nop 0
    buffer_load_dwordx4 v6, s[4:7], s50 offen lds
    s_add_u32 s50, s58, 172928
    s_add_u32 m0, s59, 73728
    s_nop 0
    buffer_load_dwordx4 v7, s[8:11], s50 offen lds
    s_add_u32 s50, s58, 194432
    s_add_u32 m0, s59, 74752
    s_nop 0
    buffer_load_dwordx4 v7, s[8:11], s50 offen lds
    s_add_u32 s50, s58, 173824
    s_add_u32 m0, s59, 81920
    s_nop 0
    buffer_load_dwordx4 v7, s[8:11], s50 offen lds
    s_add_u32 s50, s58, 195328
    s_add_u32 m0, s59, 82944
    s_nop 0
    buffer_load_dwordx4 v7, s[8:11], s50 offen lds
    s_add_u32 s50, s57, 256
    s_add_u32 m0, s59, 16384
    s_nop 0
    buffer_load_dwordx4 v5, s[4:7], s50 offen lds
    s_add_u32 s50, s57, 7424
    s_add_u32 m0, s59, 17408
    s_nop 0
    buffer_load_dwordx4 v6, s[4:7], s50 offen lds
    s_add_u32 s50, s58, 344960
    s_add_u32 m0, s59, 90112
    s_nop 0
    buffer_load_dwordx4 v7, s[8:11], s50 offen lds
    s_add_u32 s50, s58, 366464
    s_add_u32 m0, s59, 91136
    s_nop 0
    buffer_load_dwordx4 v7, s[8:11], s50 offen lds
    s_add_u32 s50, s58, 345856
    s_add_u32 m0, s59, 98304
    s_nop 0
    buffer_load_dwordx4 v7, s[8:11], s50 offen lds
    s_add_u32 s50, s58, 367360
    s_add_u32 m0, s59, 99328
    s_nop 0
    buffer_load_dwordx4 v7, s[8:11], s50 offen lds
    s_add_u32 s50, s57, 384
    s_add_u32 m0, s59, 24576
    s_nop 0
    buffer_load_dwordx4 v5, s[4:7], s50 offen lds
    s_add_u32 s50, s57, 7552
    s_add_u32 m0, s59, 25600
    s_nop 0
    buffer_load_dwordx4 v6, s[4:7], s50 offen lds
    s_add_u32 s50, s58, 516992
    s_add_u32 m0, s59, 106496
    s_nop 0
    buffer_load_dwordx4 v7, s[8:11], s50 offen lds
    s_add_u32 s50, s58, 538496
    s_add_u32 m0, s59, 107520
    s_nop 0
    buffer_load_dwordx4 v7, s[8:11], s50 offen lds
    s_add_u32 s50, s58, 517888
    s_add_u32 m0, s59, 114688
    s_nop 0
    buffer_load_dwordx4 v7, s[8:11], s50 offen lds
    s_add_u32 s50, s58, 539392
    s_add_u32 m0, s59, 115712
    s_nop 0
    buffer_load_dwordx4 v7, s[8:11], s50 offen lds
    s_mov_b32 s20, s72
    s_and_b32 s21, s73, 0xffff
    s_mov_b32 s22, 401408
    s_mov_b32 s23, 0x20000
    s_mov_b32 s12, s76
    s_and_b32 s13, s77, 0xffff
    s_mov_b32 s14, 1204224
    s_mov_b32 s15, 0x20000
    s_mov_b32 s24, s78
    s_and_b32 s25, s79, 0xffff
    s_mov_b32 s26, 401408
    s_mov_b32 s27, 0x20000
    s_mov_b32 s36, s80
    s_and_b32 s37, s81, 0xffff
    s_mov_b32 s38, 896
    s_mov_b32 s39, 0x20000
    s_mov_b32 s28, s82
    s_and_b32 s29, s83, 0xffff
    s_mov_b32 s30, 1835008
    s_mov_b32 s31, 0x20000
    s_mov_b32 s32, s84
    s_and_b32 s33, s85, 0xffff
    s_mov_b32 s34, 256
    s_mov_b32 s35, 0x20000
    s_mov_b32 s16, s86
    s_and_b32 s17, s87, 0xffff
    s_mov_b32 s18, 16973824
    s_mov_b32 s19, 0x20000
    s_lshl_b32 s45, s41, 1
    s_and_b32 s50, s42, 1
    s_add_u32 s45, s45, s50
    s_lshr_b32 s46, s2, 4
    s_lshl_b32 s47, s41, 2
    s_and_b32 s50, s42, 3
    s_add_u32 s47, s47, s50
    s_lshr_b32 s48, s42, 2
    v_mov_b32 v12, 0
    s_cmp_lg_u32 s2, 0
    s_cbranch_scc1 NONS_3
    s_cmp_lg_u32 s40, 4
    s_cbranch_scc1 NONS_3
    s_memrealtime s[50:51]
    s_waitcnt lgkmcnt(0)
    s_or_b32 s50, s50, 1
    v_mov_b32 v13, s50
    s_mov_b64 exec, 1
    buffer_store_dword v13, v12, s[32:35], 0 offen sc1
    s_mov_b64 exec, -1
NONS_3:
    s_waitcnt vmcnt(18)
    s_barrier
    s_add_u32 s50, s57, 512
    s_add_u32 m0, s59, 32768
    s_nop 0
    buffer_load_dwordx4 v5, s[4:7], s50 offen lds
    s_add_u32 s50, s57, 7680
    s_add_u32 m0, s59, 33792
    s_nop 0
    buffer_load_dwordx4 v6, s[4:7], s50 offen lds
    s_add_u32 s50, s58, 689024
    s_add_u32 m0, s59, 122880
    s_nop 0
    buffer_load_dwordx4 v7, s[8:11], s50 offen lds
    s_add_u32 s50, s58, 710528
    s_add_u32 m0, s59, 123904
    s_nop 0
    buffer_load_dwordx4 v7, s[8:11], s50 offen lds
    s_add_u32 s50, s58, 689920
    s_add_u32 m0, s59, 131072
    s_nop 0
    buffer_load_dwordx4 v7, s[8:11], s50 offen lds
    s_add_u32 s50, s58, 711424
    s_add_u32 m0, s59, 132096
    s_nop 0
    buffer_load_dwordx4 v7, s[8:11], s50 offen lds
    s_waitcnt vmcnt(18)
    s_barrier
    s_add_u32 s50, s57, 640
    s_add_u32 m0, s59, 40960
    s_nop 0
    buffer_load_dwordx4 v5, s[4:7], s50 offen lds
    s_add_u32 s50, s57, 7808
    s_add_u32 m0, s59, 41984
    s_nop 0
    buffer_load_dwordx4 v6, s[4:7], s50 offen lds
    s_add_u32 s50, s58, 861056
    s_add_u32 m0, s59, 139264
    s_nop 0
    buffer_load_dwordx4 v7, s[8:11], s50 offen lds
    s_add_u32 s50, s58, 882560
    s_add_u32 m0, s59, 140288
    s_nop 0
    buffer_load_dwordx4 v7, s[8:11], s50 offen lds
    s_add_u32 s50, s58, 861952
    s_add_u32 m0, s59, 147456
    s_nop 0
    buffer_load_dwordx4 v7, s[8:11], s50 offen lds
    s_add_u32 s50, s58, 883456
    s_add_u32 m0, s59, 148480
    s_nop 0
    buffer_load_dwordx4 v7, s[8:11], s50 offen lds
    s_waitcnt vmcnt(18)
    s_barrier
    s_add_u32 s50, s57, 768
    s_add_u32 m0, s59, 49152
    s_nop 0
    buffer_load_dwordx4 v5, s[4:7], s50 offen lds
    s_add_u32 s50, s57, 7936
    s_add_u32 m0, s59, 50176
    s_nop 0
    buffer_load_dwordx4 v6, s[4:7], s50 offen lds
    s_add_u32 s50, s58, 1033088
    s_add_u32 m0, s59, 57344
    s_nop 0
    buffer_load_dwordx4 v7, s[8:11], s50 offen lds
    s_add_u32 s50, s58, 1054592
    s_add_u32 m0, s59, 58368
    s_nop 0
    buffer_load_dwordx4 v7, s[8:11], s50 offen lds
    s_add_u32 s50, s58, 1033984
    s_add_u32 m0, s59, 65536
    s_nop 0
    buffer_load_dwordx4 v7, s[8:11], s50 offen lds
    s_add_u32 s50, s58, 1055488
    s_add_u32 m0, s59, 66560
    s_nop 0
    buffer_load_dwordx4 v7, s[8:11], s50 offen lds
    s_waitcnt vmcnt(18)
    s_barrier
    s_add_u32 s50, s58, 0
    s_add_u32 m0, s59, 73728
    s_nop 0
    buffer_load_dwordx4 v7, s[8:11], s50 offen lds
    s_add_u32 s50, s58, 21504
    s_add_u32 m0, s59, 74752
    s_nop 0
    buffer_load_dwordx4 v7, s[8:11], s50 offen lds
    s_add_u32 s50, s58, 172032
    s_add_u32 m0, s59, 81920
    s_nop 0
    buffer_load_dwordx4 v7, s[8:11], s50 offen lds
    s_add_u32 s50, s58, 193536
    s_add_u32 m0, s59, 82944
    s_nop 0
    buffer_load_dwordx4 v7, s[8:11], s50 offen lds
    s_waitcnt vmcnt(16)
    s_barrier
    s_add_u32 s50, s58, 344064
    s_add_u32 m0, s59, 90112
    s_nop 0
    buffer_load_dwordx4 v7, s[8:11], s50 offen lds
    s_add_u32 s50, s58, 365568
    s_add_u32 m0, s59, 91136
    s_nop 0
    buffer_load_dwordx4 v7, s[8:11], s50 offen lds
    s_add_u32 s50, s58, 516096
    s_add_u32 m0, s59, 98304
    s_nop 0
    buffer_load_dwordx4 v7, s[8:11], s50 offen lds
    s_add_u32 s50, s58, 537600
    s_add_u32 m0, s59, 99328
    s_nop 0
    buffer_load_dwordx4 v7, s[8:11], s50 offen lds
    s_waitcnt vmcnt(14)
    s_barrier
    s_add_u32 s50, s58, 688128
    s_add_u32 m0, s59, 106496
    s_nop 0
    buffer_load_dwordx4 v7, s[8:11], s50 offen lds
    s_add_u32 s50, s58, 709632
    s_add_u32 m0, s59, 107520
    s_nop 0
    buffer_load_dwordx4 v7, s[8:11], s50 offen lds
    s_add_u32 s50, s58, 860160
    s_add_u32 m0, s59, 114688
    s_nop 0
    buffer_load_dwordx4 v7, s[8:11], s50 offen lds
    s_add_u32 s50, s58, 881664
    s_add_u32 m0, s59, 115712
    s_nop 0
    buffer_load_dwordx4 v7, s[8:11], s50 offen lds
    s_waitcnt vmcnt(12)
    s_barrier
    s_add_u32 s50, s58, 1032192
    s_add_u32 m0, s59, 122880
    s_nop 0
    buffer_load_dwordx4 v7, s[8:11], s50 offen lds
    s_add_u32 s50, s58, 1053696
    s_add_u32 m0, s59, 123904
    s_nop 0
    buffer_load_dwordx4 v7, s[8:11], s50 offen lds
    s_waitcnt vmcnt(10)
    s_barrier
    s_add_u32 s50, s58, 0
    s_add_u32 m0, s59, 131072
    s_nop 0
    buffer_load_dwordx4 v7, s[12:15], s50 offen lds
    s_add_u32 s50, s58, 21504
    s_add_u32 m0, s59, 132096
    s_nop 0
    buffer_load_dwordx4 v7, s[12:15], s50 offen lds
    s_add_u32 s50, s58, 896
    s_add_u32 m0, s59, 139264
    s_nop 0
    buffer_load_dwordx4 v7, s[12:15], s50 offen lds
    s_add_u32 s50, s58, 22400
    s_add_u32 m0, s59, 140288
    s_nop 0
    buffer_load_dwordx4 v7, s[12:15], s50 offen lds
    s_add_u32 s50, s58, 1792
    s_add_u32 m0, s59, 147456
    s_nop 0
    buffer_load_dwordx4 v7, s[12:15], s50 offen lds
    s_add_u32 s50, s58, 23296
    s_add_u32 m0, s59, 148480
    s_nop 0
    buffer_load_dwordx4 v7, s[12:15], s50 offen lds
    s_waitcnt vmcnt(12)
    s_barrier
    s_waitcnt vmcnt(8)
    s_barrier
    s_add_u32 s50, s58, 172032
    s_add_u32 m0, s59, 57344
    s_nop 0
    buffer_load_dwordx4 v7, s[12:15], s50 offen lds
    s_add_u32 s50, s58, 193536
    s_add_u32 m0, s59, 58368
    s_nop 0
    buffer_load_dwordx4 v7, s[12:15], s50 offen lds
    s_add_u32 s50, s58, 172928
    s_add_u32 m0, s59, 65536
    s_nop 0
    buffer_load_dwordx4 v7, s[12:15], s50 offen lds
    s_add_u32 s50, s58, 194432
    s_add_u32 m0, s59, 66560
    s_nop 0
    buffer_load_dwordx4 v7, s[12:15], s50 offen lds
    s_add_u32 s50, s58, 173824
    s_add_u32 m0, s59, 73728
    s_nop 0
    buffer_load_dwordx4 v7, s[12:15], s50 offen lds
    s_add_u32 s50, s58, 195328
    s_add_u32 m0, s59, 74752
    s_nop 0
    buffer_load_dwordx4 v7, s[12:15], s50 offen lds
    v_mov_b32 v12, 0
    buffer_load_dword v14, v12, s[32:35], 0 offen sc1
    s_waitcnt vmcnt(13)
    s_barrier
    s_waitcnt vmcnt(7)
    s_barrier
    s_add_u32 s50, s58, 344064
    s_add_u32 m0, s59, 81920
    s_nop 0
    buffer_load_dwordx4 v7, s[12:15], s50 offen lds
    s_add_u32 s50, s58, 365568
    s_add_u32 m0, s59, 82944
    s_nop 0
    buffer_load_dwordx4 v7, s[12:15], s50 offen lds
    s_add_u32 s50, s58, 344960
    s_add_u32 m0, s59, 90112
    s_nop 0
    buffer_load_dwordx4 v7, s[12:15], s50 offen lds
    s_add_u32 s50, s58, 366464
    s_add_u32 m0, s59, 91136
    s_nop 0
    buffer_load_dwordx4 v7, s[12:15], s50 offen lds
    s_add_u32 s50, s58, 345856
    s_add_u32 m0, s59, 98304
    s_nop 0
    buffer_load_dwordx4 v7, s[12:15], s50 offen lds
    s_add_u32 s50, s58, 367360
    s_add_u32 m0, s59, 99328
    s_nop 0
    buffer_load_dwordx4 v7, s[12:15], s50 offen lds
    s_waitcnt vmcnt(7)
    s_barrier
    s_add_u32 s50, s58, 516096
    s_add_u32 m0, s59, 106496
    s_nop 0
    buffer_load_dwordx4 v7, s[12:15], s50 offen lds
    s_add_u32 s50, s58, 537600
    s_add_u32 m0, s59, 107520
    s_nop 0
    buffer_load_dwordx4 v7, s[12:15], s50 offen lds
    s_add_u32 s50, s58, 516992
    s_add_u32 m0, s59, 114688
    s_nop 0
    buffer_load_dwordx4 v7, s[12:15], s50 offen lds
    s_add_u32 s50, s58, 538496
    s_add_u32 m0, s59, 115712
    s_nop 0
    buffer_load_dwordx4 v7, s[12:15], s50 offen lds
    s_add_u32 s50, s58, 517888
    s_add_u32 m0, s59, 122880
    s_nop 0
    buffer_load_dwordx4 v7, s[12:15], s50 offen lds
    s_add_u32 s50, s58, 539392
    s_add_u32 m0, s59, 123904
    s_nop 0
    buffer_load_dwordx4 v7, s[12:15], s50 offen lds
    s_waitcnt vmcnt(6)
    s_barrier
    s_add_u32 s50, s58, 688128
    s_add_u32 m0, s59, 131072
    s_nop 0
    buffer_load_dwordx4 v7, s[12:15], s50 offen lds
    s_add_u32 s50, s58, 709632
    s_add_u32 m0, s59, 132096
    s_nop 0
    buffer_load_dwordx4 v7, s[12:15], s50 offen lds
    s_add_u32 s50, s58, 689024
    s_add_u32 m0, s59, 139264
    s_nop 0
    buffer_load_dwordx4 v7, s[12:15], s50 offen lds
    s_add_u32 s50, s58, 710528
    s_add_u32 m0, s59, 140288
    s_nop 0
    buffer_load_dwordx4 v7, s[12:15], s50 offen lds
    s_add_u32 s50, s58, 689920
    s_add_u32 m0, s59, 147456
    s_nop 0
    buffer_load_dwordx4 v7, s[12:15], s50 offen lds
    s_add_u32 s50, s58, 711424
    s_add_u32 m0, s59, 148480
    s_nop 0
    buffer_load_dwordx4 v7, s[12:15], s50 offen lds
    s_waitcnt vmcnt(6)
    s_barrier
    s_add_u32 s50, s58, 860160
    s_add_u32 m0, s59, 57344
    s_nop 0
    buffer_load_dwordx4 v7, s[12:15], s50 offen lds
    s_add_u32 s50, s58, 881664
    s_add_u32 m0, s59, 58368
    s_nop 0
    buffer_load_dwordx4 v7, s[12:15], s50 offen lds
    s_add_u32 s50, s58, 861056
    s_add_u32 m0, s59, 65536
    s_nop 0
    buffer_load_dwordx4 v7, s[12:15], s50 offen lds
    s_add_u32 s50, s58, 882560
    s_add_u32 m0, s59, 66560
    s_nop 0
    buffer_load_dwordx4 v7, s[12:15], s50 offen lds
    s_add_u32 s50, s58, 861952
    s_add_u32 m0, s59, 73728
    s_nop 0
    buffer_load_dwordx4 v7, s[12:15], s50 offen lds
    s_add_u32 s50, s58, 883456
    s_add_u32 m0, s59, 74752
    s_nop 0
    buffer_load_dwordx4 v7, s[12:15], s50 offen lds
    s_waitcnt vmcnt(6)
    s_barrier
    s_add_u32 s50, s58, 1032192
    s_add_u32 m0, s59, 81920
    s_nop 0
    buffer_load_dwordx4 v7, s[12:15], s50 offen lds
    s_add_u32 s50, s58, 1053696
    s_add_u32 m0, s59, 82944
    s_nop 0
    buffer_load_dwordx4 v7, s[12:15], s50 offen lds
    s_add_u32 s50, s58, 1033088
    s_add_u32 m0, s59, 90112
    s_nop 0
    buffer_load_dwordx4 v7, s[12:15], s50 offen lds
    s_add_u32 s50, s58, 1054592
    s_add_u32 m0, s59, 91136
    s_nop 0
    buffer_load_dwordx4 v7, s[12:15], s50 offen lds
    s_add_u32 s50, s58, 1033984
    s_add_u32 m0, s59, 98304
    s_nop 0
    buffer_load_dwordx4 v7, s[12:15], s50 offen lds
    s_add_u32 s50, s58, 1055488
    s_add_u32 m0, s59, 99328
    s_nop 0
    buffer_load_dwordx4 v7, s[12:15], s50 offen lds
    s_waitcnt vmcnt(6)
    s_barrier
    v_readfirstlane_b32 s49, v14
    s_nop 0
    s_cmp_lg_u32 s49, 0
    s_cbranch_scc1 NOND_5
    v_mov_b32 v12, 0
    s_mov_b32 s51, 0
NON_4:
    buffer_load_dword v13, v12, s[32:35], 0 offen sc1
    s_waitcnt vmcnt(0)
    v_readfirstlane_b32 s49, v13
    s_nop 0
    s_cmp_lg_u32 s49, 0
    s_cbranch_scc1 NOND_5
    s_sleep 4
    s_add_u32 s51, s51, 1
    s_cmp_lt_u32 s51, 40000
    s_cbranch_scc1 NON_4
NOND_5:
    s_lshl_b32 s60, s46, 1
    s_lshr_b32 s50, s56, 1
    s_add_u32 s60, s60, s50
    s_mul_i32 s61, s45, 28
    v_mov_b32 v12, 0
    s_mov_b64 exec, 1
    s_add_u32 s50, s61, 0
    s_lshr_b32 s50, s50, 6
    s_and_b32 s51, s50, 3
    s_lshl_b32 s51, s51, 3
    s_and_b32 s52, s60, 7
    s_add_u32 s51, s51, s52
    s_lshr_b32 s52, s50, 2
    s_and_b32 s53, s60, 3
    s_add_u32 s53, s53, 24
    s_bfe_u32 s54, s60, 0x10002
    s_cmp_eq_u32 s50, 3
    s_cselect_b32 s51, s53, s51
    s_cselect_b32 s52, s54, s52
    s_lshl_b32 s51, s51, 3
    s_add_u32 s51, s51, s52
    s_lshr_b32 s52, s60, 3
    s_lshl_b32 s52, s52, 1
    s_add_u32 s51, s51, s52
    s_lshl_b32 s51, s51, 6
    s_add_u32 s51, s51, 16842752
    buffer_load_dword v140, v12, s[16:19], s51 offen sc1
    s_add_u32 s50, s61, 27
    s_lshr_b32 s50, s50, 6
    s_and_b32 s51, s50, 3
    s_lshl_b32 s51, s51, 3
    s_and_b32 s52, s60, 7
    s_add_u32 s51, s51, s52
    s_lshr_b32 s52, s50, 2
    s_and_b32 s53, s60, 3
    s_add_u32 s53, s53, 24
    s_bfe_u32 s54, s60, 0x10002
    s_cmp_eq_u32 s50, 3
    s_cselect_b32 s51, s53, s51
    s_cselect_b32 s52, s54, s52
    s_lshl_b32 s51, s51, 3
    s_add_u32 s51, s51, s52
    s_lshr_b32 s52, s60, 3
    s_lshl_b32 s52, s52, 1
    s_add_u32 s51, s51, s52
    s_lshl_b32 s51, s51, 6
    s_add_u32 s51, s51, 16842752
    buffer_load_dword v141, v12, s[16:19], s51 offen sc1
    s_mov_b64 exec, -1
    s_waitcnt vmcnt(2)
    s_barrier
    s_waitcnt vmcnt(0)
    s_mov_b32 s63, 0
    v_readfirstlane_b32 s50, v140
    v_readfirstlane_b32 s51, v141
    s_cmp_lg_u32 s50, s49
    s_cbranch_scc1 NOQ_6
    s_cmp_lg_u32 s51, s49
    s_cbranch_scc1 NOQ_6
    s_mov_b32 s63, 1
    s_cmp_eq_u32 s40, 4
    s_cbranch_scc1 QSK_7
    s_sub_u32 s52, s40, 4
    s_lshl_b32 s50, s46, 2
    s_add_u32 s50, s50, s52
    s_mul_i32 s50, s50, 28672
    s_mul_i32 s51, s45, 1792
    s_add_u32 s50, s50, s51
    s_lshl_b32 s51, s52, 11
    s_add_u32 m0, s51, 155648
    s_nop 0
    buffer_load_dwordx4 v1, s[16:19], s50 offen lds
    s_mov_b32 exec_hi, 0xffff
    buffer_load_dwordx4 v1, s[16:19], s50 offen offset:1024 lds
    s_mov_b32 exec_hi, -1
    s_cmp_lg_u32 s40, 5
    s_cbranch_scc1 QSK_7
    s_mov_b32 s52, 0
    s_lshl_b32 s50, s46, 2
    s_add_u32 s50, s50, s52
    s_mul_i32 s50, s50, 28672
    s_mul_i32 s51, s45, 1792
    s_add_u32 s50, s50, s51
    s_lshl_b32 s51, s52, 11
    s_add_u32 m0, s51, 155648
    s_nop 0
    buffer_load_dwordx4 v1, s[16:19], s50 offen lds
    s_mov_b32 exec_hi, 0xffff
    buffer_load_dwordx4 v1, s[16:19], s50 offen offset:1024 lds
    s_mov_b32 exec_hi, -1
QSK_7:
NOQ_6:
    s_cmp_lg_u32 s40, 4
    s_cbranch_scc1 POLLD_10
    s_mov_b32 s50, 16842752
    s_mov_b32 s92, 16846848
    s_mov_b32 s93, 16850944
    s_mov_b32 s94, 16855040
    v_lshlrev_b32 v11, 6, v0
    s_mov_b32 s51, 0
    s_mov_b64 s[52:53], -1
    s_mov_b64 s[54:55], -1
    s_mov_b64 s[88:89], -1
    s_mov_b64 s[90:91], -1
POLL_9:
    s_mov_b64 exec, s[52:53]
    s_cbranch_execz PSK_11
    buffer_load_dword v12, v11, s[16:19], s50 offen sc1
PSK_11:
    s_mov_b64 exec, s[54:55]
    s_cbranch_execz PSK_12
    buffer_load_dword v13, v11, s[16:19], s92 offen sc1
PSK_12:
    s_mov_b64 exec, s[88:89]
    s_cbranch_execz PSK_13
    buffer_load_dword v14, v11, s[16:19], s93 offen sc1
PSK_13:
    s_mov_b64 exec, s[90:91]
    s_cbranch_execz PSK_14
    buffer_load_dword v15, v11, s[16:19], s94 offen sc1
PSK_14:
    s_waitcnt vmcnt(0)
    s_mov_b64 exec, s[52:53]
    v_cmp_ne_u32 s[52:53], s49, v12
    s_mov_b64 exec, s[54:55]
    v_cmp_ne_u32 s[54:55], s49, v13
    s_mov_b64 exec, s[88:89]
    v_cmp_ne_u32 s[88:89], s49, v14
    s_mov_b64 exec, s[90:91]
    v_cmp_ne_u32 s[90:91], s49, v15
    s_mov_b64 exec, -1
    s_or_b64 vcc, s[52:53], s[54:55]
    s_or_b64 vcc, vcc, s[88:89]
    s_or_b64 vcc, vcc, s[90:91]
    s_cmp_eq_u64 vcc, 0
    s_cbranch_scc1 POLLD_10
    s_sleep 4
    s_add_u32 s51, s51, 1
    s_cmp_lt_u32 s51, 40000
    s_cbranch_scc1 POLL_9
POLLD_10:
    s_barrier
ATT_H_ENTRY:
    s_sub_u32 s56, s40, 4
    v_and_b32 v2, 31, v0
    v_lshrrev_b32 v3, 5, v0
    v_lshlrev_b32 v4, 4, v2
    s_movk_i32 s50, 7168
    v_mad_u32_u24 v4, v3, s50, v4
    v_lshlrev_b32 v5, 3, v2
    v_lshl_add_u32 v5, v3, 8, v5
    s_lshl_b32 s57, s56, 4
    s_mul_i32 s57, s57, 28672
    s_mul_i32 s50, s45, 1792
    s_add_u32 s58, s57, s50
    s_add_u32 s58, s58, 2097152
    s_mul_i32 s50, s45, 448
    s_add_u32 s59, s57, s50
    s_add_u32 s59, s59, 4194304
    s_lshl_b32 s60, s56, 13
    v_lshlrev_b32 v6, 3, v0
    v_add_u32 v6, s60, v6
    v_add_u32 v6, 59136, v6
    v_mov_b32 v8, 0x3f80
    v_mov_b32 v9, 0
    v_and_b32 v7, 3, v0
    v_cmp_eq_u32 vcc, 0, v7
    v_mov_b32 v16, 0
    v_mov_b32 v17, 0x3f803f80
    v_cndmask_b32 v16, v16, v17, vcc
    v_mov_b32 v17, v16
    v_mov_b32 v18, v16
    v_mov_b32 v19, v16
    v_bfe_u32 v10, v0, 2, 1
    v_lshl_add_u32 v7, v10, 5, v7
    v_bfe_u32 v10, v0, 3, 1
    v_lshl_add_u32 v7, v10, 6, v7
    v_lshlrev_b32 v7, 4, v7
    v_add_u32 v7, s60, v7
    v_add_u32 v7, 59840, v7
    s_cmp_lg_u32 s63, 0
    s_cbranch_scc1 HAVE_Q
    s_cmp_eq_u32 s40, 4
    s_cbranch_scc1 QSK_15
    s_sub_u32 s52, s40, 4
    s_lshl_b32 s50, s46, 2
    s_add_u32 s50, s50, s52
    s_mul_i32 s50, s50, 28672
    s_mul_i32 s51, s45, 1792
    s_add_u32 s50, s50, s51
    s_lshl_b32 s51, s52, 11
    s_add_u32 m0, s51, 155648
    s_nop 0
    buffer_load_dwordx4 v1, s[16:19], s50 offen lds
    s_mov_b32 exec_hi, 0xffff
    buffer_load_dwordx4 v1, s[16:19], s50 offen offset:1024 lds
    s_mov_b32 exec_hi, -1
    s_cmp_lg_u32 s40, 5
    s_cbranch_scc1 QSK_15
    s_mov_b32 s52, 0
    s_lshl_b32 s50, s46, 2
    s_add_u32 s50, s50, s52
    s_mul_i32 s50, s50, 28672
    s_mul_i32 s51, s45, 1792
    s_add_u32 s50, s50, s51
    s_lshl_b32 s51, s52, 11
    s_add_u32 m0, s51, 155648
    s_nop 0
    buffer_load_dwordx4 v1, s[16:19], s50 offen lds
    s_mov_b32 exec_hi, 0xffff
    buffer_load_dwordx4 v1, s[16:19], s50 offen offset:1024 lds
    s_mov_b32 exec_hi, -1
QSK_15:
HAVE_Q:
    s_add_u32 s51, s46, 0
    s_and_b32 s51, s51, 7
    s_mul_i32 s51, s51, 0
    s_mov_b32 s51, 0
    s_add_u32 s52, s51, s58
    s_add_u32 s53, s51, s59
    s_add_u32 s50, s52, 0
    s_add_u32 m0, s60, 90112
    s_nop 0
    buffer_load_dwordx4 v1, s[16:19], s50 offen lds
    s_mov_b32 exec_hi, 0xffff
    buffer_load_dwordx4 v1, s[16:19], s50 offen offset:1024 lds
    s_mov_b32 exec_lo, 0x0fffffff
    s_mov_b32 exec_hi, 0x0fffffff
    s_add_u32 s50, s53, 0
    s_add_u32 m0, s60, 92160
    s_nop 0
    buffer_load_dwordx4 v4, s[16:19], s50 offen lds
    s_add_u32 s50, s53, 14336
    s_add_u32 m0, s60, 93184
    s_nop 0
    buffer_load_dwordx4 v4, s[16:19], s50 offen lds
    s_mov_b64 exec, -1
    s_add_u32 s50, s52, 28672
    s_add_u32 m0, s60, 94208
    s_nop 0
    buffer_load_dwordx4 v1, s[16:19], s50 offen lds
    s_mov_b32 exec_hi, 0xffff
    buffer_load_dwordx4 v1, s[16:19], s50 offen offset:1024 lds
    s_mov_b32 exec_lo, 0x0fffffff
    s_mov_b32 exec_hi, 0x0fffffff
    s_add_u32 s50, s53, 28672
    s_add_u32 m0, s60, 96256
    s_nop 0
    buffer_load_dwordx4 v4, s[16:19], s50 offen lds
    s_add_u32 s50, s53, 43008
    s_add_u32 m0, s60, 97280
    s_nop 0
    buffer_load_dwordx4 v4, s[16:19], s50 offen lds
    s_mov_b64 exec, -1
    s_mov_b32 exec_hi, 0
    ds_write_b64 v6, v[8:9] offset:32768
    s_mov_b32 exec_lo, 0xffff
    ds_write_b128 v7, v[16:19] offset:32768
    s_mov_b64 exec, -1
    s_mov_b32 exec_hi, 0
    ds_write_b64 v6, v[8:9] offset:36864
    s_mov_b32 exec_lo, 0xffff
    ds_write_b128 v7, v[16:19] offset:36864
    s_mov_b64 exec, -1
    s_mov_b32 exec_hi, 0
    ds_write_b64 v6, v[8:9] offset:0
    s_mov_b32 exec_lo, 0xffff
    ds_write_b128 v7, v[16:19] offset:0
    s_mov_b64 exec, -1
    s_mov_b32 exec_hi, 0
    ds_write_b64 v6, v[8:9] offset:4096
    s_mov_b32 exec_lo, 0xffff
    ds_write_b128 v7, v[16:19] offset:4096
    s_mov_b64 exec, -1
    v_add_u32 v10, 65536, v6
    v_add_u32 v11, 65536, v7
    s_mov_b32 exec_hi, 0
    ds_write_b64 v10, v[8:9] offset:0
    s_mov_b32 exec_lo, 0xffff
    ds_write_b128 v11, v[16:19] offset:0
    s_mov_b64 exec, -1
    v_add_u32 v10, 69632, v6
    v_add_u32 v11, 69632, v7
    s_mov_b32 exec_hi, 0
    ds_write_b64 v10, v[8:9] offset:0
    s_mov_b32 exec_lo, 0xffff
    ds_write_b128 v11, v[16:19] offset:0
    s_mov_b64 exec, -1
    v_mov_b32 v10, 157440
    v_mov_b32 v11, 0
    ds_write_b32 v10, v11
    s_add_u32 s51, s46, 1
    s_and_b32 s51, s51, 7
    s_mul_i32 s51, s51, 0
    s_mov_b32 s51, 57344
    s_add_u32 s52, s51, s58
    s_add_u32 s53, s51, s59
    s_add_u32 s50, s52, 0
    s_add_u32 m0, s60, 57344
    s_nop 0
    buffer_load_dwordx4 v1, s[16:19], s50 offen lds
    s_mov_b32 exec_hi, 0xffff
    buffer_load_dwordx4 v1, s[16:19], s50 offen offset:1024 lds
    s_mov_b32 exec_lo, 0x0fffffff
    s_mov_b32 exec_hi, 0x0fffffff
    s_add_u32 s50, s53, 0
    s_add_u32 m0, s60, 59392
    s_nop 0
    buffer_load_dwordx4 v4, s[16:19], s50 offen lds
    s_add_u32 s50, s53, 14336
    s_add_u32 m0, s60, 60416
    s_nop 0
    buffer_load_dwordx4 v4, s[16:19], s50 offen lds
    s_mov_b64 exec, -1
    s_add_u32 s50, s52, 28672
    s_add_u32 m0, s60, 61440
    s_nop 0
    buffer_load_dwordx4 v1, s[16:19], s50 offen lds
    s_mov_b32 exec_hi, 0xffff
    buffer_load_dwordx4 v1, s[16:19], s50 offen offset:1024 lds
    s_mov_b32 exec_lo, 0x0fffffff
    s_mov_b32 exec_hi, 0x0fffffff
    s_add_u32 s50, s53, 28672
    s_add_u32 m0, s60, 63488
    s_nop 0
    buffer_load_dwordx4 v4, s[16:19], s50 offen lds
    s_add_u32 s50, s53, 43008
    s_add_u32 m0, s60, 64512
    s_nop 0
    buffer_load_dwordx4 v4, s[16:19], s50 offen lds
    s_mov_b64 exec, -1
    s_waitcnt vmcnt(8) lgkmcnt(0)
    s_barrier
    s_add_u32 s51, s46, 2
    s_and_b32 s51, s51, 7
    s_mul_i32 s51, s51, 0
    s_mov_b32 s51, 114688
    s_add_u32 s52, s51, s58
    s_add_u32 s53, s51, s59
    s_add_u32 s50, s52, 0
    s_add_u32 m0, s60, 122880
    s_nop 0
    buffer_load_dwordx4 v1, s[16:19], s50 offen lds
    s_mov_b32 exec_hi, 0xffff
    buffer_load_dwordx4 v1, s[16:19], s50 offen offset:1024 lds
    s_mov_b32 exec_lo, 0x0fffffff
    s_mov_b32 exec_hi, 0x0fffffff
    s_add_u32 s50, s53, 0
    s_add_u32 m0, s60, 124928
    s_nop 0
    buffer_load_dwordx4 v4, s[16:19], s50 offen lds
    s_add_u32 s50, s53, 14336
    s_add_u32 m0, s60, 125952
    s_nop 0
    buffer_load_dwordx4 v4, s[16:19], s50 offen lds
    s_mov_b64 exec, -1
    s_add_u32 s50, s52, 28672
    s_add_u32 m0, s60, 126976
    s_nop 0
    buffer_load_dwordx4 v1, s[16:19], s50 offen lds
    s_mov_b32 exec_hi, 0xffff
    buffer_load_dwordx4 v1, s[16:19], s50 offen offset:1024 lds
    s_mov_b32 exec_lo, 0x0fffffff
    s_mov_b32 exec_hi, 0x0fffffff
    s_add_u32 s50, s53, 28672
    s_add_u32 m0, s60, 129024
    s_nop 0
    buffer_load_dwordx4 v4, s[16:19], s50 offen lds
    s_add_u32 s50, s53, 43008
    s_add_u32 m0, s60, 130048
    s_nop 0
    buffer_load_dwordx4 v4, s[16:19], s50 offen lds
    s_mov_b64 exec, -1
    v_lshrrev_b32 v10, 3, v0
    v_and_b32 v11, 7, v0
    v_bfe_u32 v12, v0, 4, 1
    v_lshlrev_b32 v12, 2, v12
    v_xor_b32 v11, v11, v12
    v_lshlrev_b32 v11, 4, v11
    s_movk_i32 s50, 896
    v_mad_u32_u24 v10, v10, s50, v11
    s_mul_i32 s51, s56, 100352
    s_lshl_b32 s50, s48, 7
    s_add_u32 s51, s51, s50
    s_mul_i32 s52, s56, 14336
    s_add_u32 s50, s51, 0
    s_add_u32 m0, s52, 0
    s_nop 0
    buffer_load_dwordx4 v10, s[24:27], s50 offen lds
    s_add_u32 s50, s51, 7168
    s_add_u32 m0, s52, 1024
    s_nop 0
    buffer_load_dwordx4 v10, s[24:27], s50 offen lds
    s_add_u32 s50, s51, 14336
    s_add_u32 m0, s52, 2048
    s_nop 0
    buffer_load_dwordx4 v10, s[24:27], s50 offen lds
    s_add_u32 s50, s51, 21504
    s_add_u32 m0, s52, 3072
    s_nop 0
    buffer_load_dwordx4 v10, s[24:27], s50 offen lds
    s_add_u32 s50, s51, 28672
    s_add_u32 m0, s52, 4096
    s_nop 0
    buffer_load_dwordx4 v10, s[24:27], s50 offen lds
    s_add_u32 s50, s51, 35840
    s_add_u32 m0, s52, 5120
    s_nop 0
    buffer_load_dwordx4 v10, s[24:27], s50 offen lds
    s_add_u32 s50, s51, 43008
    s_add_u32 m0, s52, 6144
    s_nop 0
    buffer_load_dwordx4 v10, s[24:27], s50 offen lds
    s_waitcnt vmcnt(15) lgkmcnt(0)
    s_barrier
    s_add_u32 s51, s46, 3
    s_and_b32 s51, s51, 7
    s_mul_i32 s51, s51, 0
    s_mov_b32 s51, 172032
    s_add_u32 s52, s51, s58
    s_add_u32 s53, s51, s59
    s_add_u32 s50, s52, 0
    s_add_u32 m0, s60, 90112
    s_nop 0
    buffer_load_dwordx4 v1, s[16:19], s50 offen lds
    s_mov_b32 exec_hi, 0xffff
    buffer_load_dwordx4 v1, s[16:19], s50 offen offset:1024 lds
    s_mov_b32 exec_lo, 0x0fffffff
    s_mov_b32 exec_hi, 0x0fffffff
    s_add_u32 s50, s53, 0
    s_add_u32 m0, s60, 92160
    s_nop 0
    buffer_load_dwordx4 v4, s[16:19], s50 offen lds
    s_add_u32 s50, s53, 14336
    s_add_u32 m0, s60, 93184
    s_nop 0
    buffer_load_dwordx4 v4, s[16:19], s50 offen lds
    s_mov_b64 exec, -1
    s_add_u32 s50, s52, 28672
    s_add_u32 m0, s60, 94208
    s_nop 0
    buffer_load_dwordx4 v1, s[16:19], s50 offen lds
    s_mov_b32 exec_hi, 0xffff
    buffer_load_dwordx4 v1, s[16:19], s50 offen offset:1024 lds
    s_mov_b32 exec_lo, 0x0fffffff
    s_mov_b32 exec_hi, 0x0fffffff
    s_add_u32 s50, s53, 28672
    s_add_u32 m0, s60, 96256
    s_nop 0
    buffer_load_dwordx4 v4, s[16:19], s50 offen lds
    s_add_u32 s50, s53, 43008
    s_add_u32 m0, s60, 97280
    s_nop 0
    buffer_load_dwordx4 v4, s[16:19], s50 offen lds
    s_mov_b64 exec, -1
    v_lshrrev_b32 v10, 3, v0
    v_and_b32 v11, 7, v0
    v_bfe_u32 v12, v0, 4, 1
    v_lshlrev_b32 v12, 2, v12
    v_xor_b32 v11, v11, v12
    v_lshlrev_b32 v11, 4, v11
    s_movk_i32 s50, 896
    v_mad_u32_u24 v10, v10, s50, v11
    s_mul_i32 s51, s56, 100352
    s_lshl_b32 s50, s48, 7
    s_add_u32 s51, s51, s50
    s_mul_i32 s52, s56, 14336
    s_add_u32 s50, s51, 50176
    s_add_u32 m0, s52, 7168
    s_nop 0
    buffer_load_dwordx4 v10, s[24:27], s50 offen lds
    s_add_u32 s50, s51, 57344
    s_add_u32 m0, s52, 8192
    s_nop 0
    buffer_load_dwordx4 v10, s[24:27], s50 offen lds
    s_add_u32 s50, s51, 64512
    s_add_u32 m0, s52, 9216
    s_nop 0
    buffer_load_dwordx4 v10, s[24:27], s50 offen lds
    s_add_u32 s50, s51, 71680
    s_add_u32 m0, s52, 10240
    s_nop 0
    buffer_load_dwordx4 v10, s[24:27], s50 offen lds
    s_add_u32 s50, s51, 78848
    s_add_u32 m0, s52, 11264
    s_nop 0
    buffer_load_dwordx4 v10, s[24:27], s50 offen lds
    s_add_u32 s50, s51, 86016
    s_add_u32 m0, s52, 12288
    s_nop 0
    buffer_load_dwordx4 v10, s[24:27], s50 offen lds
    s_add_u32 s50, s51, 93184
    s_add_u32 m0, s52, 13312
    s_nop 0
    buffer_load_dwordx4 v10, s[24:27], s50 offen lds
    s_waitcnt vmcnt(22) lgkmcnt(0)
    s_barrier
    v_lshlrev_b32 v11, 6, v0
    s_mov_b32 s50, 16859136
    buffer_load_dword v140, v11, s[16:19], s50 offen sc1
    s_mov_b32 s50, 16863232
    buffer_load_dword v141, v11, s[16:19], s50 offen sc1
    s_mov_b32 s50, 16867328
    buffer_load_dword v142, v11, s[16:19], s50 offen sc1
    s_mov_b32 s50, 16871424
    buffer_load_dword v143, v11, s[16:19], s50 offen sc1
    s_add_u32 s51, s46, 4
    s_and_b32 s51, s51, 7
    s_mul_i32 s51, s51, 0
    s_mov_b32 s51, 229376
    s_add_u32 s52, s51, s58
    s_add_u32 s53, s51, s59
    s_add_u32 s50, s52, 0
    s_add_u32 m0, s60, 57344
    s_nop 0
    buffer_load_dwordx4 v1, s[16:19], s50 offen lds
    s_mov_b32 exec_hi, 0xffff
    buffer_load_dwordx4 v1, s[16:19], s50 offen offset:1024 lds
    s_mov_b32 exec_lo, 0x0fffffff
    s_mov_b32 exec_hi, 0x0fffffff
    s_add_u32 s50, s53, 0
    s_add_u32 m0, s60, 59392
    s_nop 0
    buffer_load_dwordx4 v4, s[16:19], s50 offen lds
    s_add_u32 s50, s53, 14336
    s_add_u32 m0, s60, 60416
    s_nop 0
    buffer_load_dwordx4 v4, s[16:19], s50 offen lds
    s_mov_b64 exec, -1
    s_add_u32 s50, s52, 28672
    s_add_u32 m0, s60, 61440
    s_nop 0
    buffer_load_dwordx4 v1, s[16:19], s50 offen lds
    s_mov_b32 exec_hi, 0xffff
    buffer_load_dwordx4 v1, s[16:19], s50 offen offset:1024 lds
    s_mov_b32 exec_lo, 0x0fffffff
    s_mov_b32 exec_hi, 0x0fffffff
    s_add_u32 s50, s53, 28672
    s_add_u32 m0, s60, 63488
    s_nop 0
    buffer_load_dwordx4 v4, s[16:19], s50 offen lds
    s_add_u32 s50, s53, 43008
    s_add_u32 m0, s60, 64512
    s_nop 0
    buffer_load_dwordx4 v4, s[16:19], s50 offen lds
    s_mov_b64 exec, -1
    s_waitcnt vmcnt(8)
    v_cmp_eq_u32 s[52:53], s49, v140
    v_cmp_eq_u32 s[54:55], s49, v141
    s_nop 0
    s_and_b64 s[52:53], s[52:53], s[54:55]
    v_cmp_eq_u32 s[54:55], s49, v142
    s_nop 0
    s_and_b64 s[52:53], s[52:53], s[54:55]
    v_cmp_eq_u32 s[54:55], s49, v143
    s_nop 0
    s_and_b64 s[52:53], s[52:53], s[54:55]
    s_cmp_eq_u64 s[52:53], -1
    s_cbranch_scc1 PCK_17
    s_waitcnt vmcnt(0)
    s_cmp_lg_u32 s40, 4
    s_cbranch_scc1 POLLD_19
    s_mov_b32 s50, 16859136
    s_mov_b32 s92, 16863232
    s_mov_b32 s93, 16867328
    s_mov_b32 s94, 16871424
    v_lshlrev_b32 v11, 6, v0
    s_mov_b32 s51, 0
    s_mov_b64 s[52:53], -1
    s_mov_b64 s[54:55], -1
    s_mov_b64 s[88:89], -1
    s_mov_b64 s[90:91], -1
POLL_18:
    s_mov_b64 exec, s[52:53]
    s_cbranch_execz PSK_20
    buffer_load_dword v12, v11, s[16:19], s50 offen sc1
PSK_20:
    s_mov_b64 exec, s[54:55]
    s_cbranch_execz PSK_21
    buffer_load_dword v13, v11, s[16:19], s92 offen sc1
PSK_21:
    s_mov_b64 exec, s[88:89]
    s_cbranch_execz PSK_22
    buffer_load_dword v14, v11, s[16:19], s93 offen sc1
PSK_22:
    s_mov_b64 exec, s[90:91]
    s_cbranch_execz PSK_23
    buffer_load_dword v15, v11, s[16:19], s94 offen sc1
PSK_23:
    s_waitcnt vmcnt(0)
    s_mov_b64 exec, s[52:53]
    v_cmp_ne_u32 s[52:53], s49, v12
    s_mov_b64 exec, s[54:55]
    v_cmp_ne_u32 s[54:55], s49, v13
    s_mov_b64 exec, s[88:89]
    v_cmp_ne_u32 s[88:89], s49, v14
    s_mov_b64 exec, s[90:91]
    v_cmp_ne_u32 s[90:91], s49, v15
    s_mov_b64 exec, -1
    s_or_b64 vcc, s[52:53], s[54:55]
    s_or_b64 vcc, vcc, s[88:89]
    s_or_b64 vcc, vcc, s[90:91]
    s_cmp_eq_u64 vcc, 0
    s_cbranch_scc1 POLLD_19
    s_sleep 4
    s_add_u32 s51, s51, 1
    s_cmp_lt_u32 s51, 40000
    s_cbranch_scc1 POLL_18
POLLD_19:
PCK_17:
    s_barrier
    s_add_u32 s51, s46, 5
    s_and_b32 s51, s51, 7
    s_mul_i32 s51, s51, 0
    s_mov_b32 s51, 286720
    s_add_u32 s52, s51, s58
    s_add_u32 s53, s51, s59
    s_add_u32 s50, s52, 0
    s_add_u32 m0, s60, 122880
    s_nop 0
    buffer_load_dwordx4 v1, s[16:19], s50 offen lds
    s_mov_b32 exec_hi, 0xffff
    buffer_load_dwordx4 v1, s[16:19], s50 offen offset:1024 lds
    s_mov_b32 exec_lo, 0x0fffffff
    s_mov_b32 exec_hi, 0x0fffffff
    s_add_u32 s50, s53, 0
    s_add_u32 m0, s60, 124928
    s_nop 0
    buffer_load_dwordx4 v4, s[16:19], s50 offen lds
    s_add_u32 s50, s53, 14336
    s_add_u32 m0, s60, 125952
    s_nop 0
    buffer_load_dwordx4 v4, s[16:19], s50 offen lds
    s_mov_b64 exec, -1
    s_add_u32 s50, s52, 28672
    s_add_u32 m0, s60, 126976
    s_nop 0
    buffer_load_dwordx4 v1, s[16:19], s50 offen lds
    s_mov_b32 exec_hi, 0xffff
    buffer_load_dwordx4 v1, s[16:19], s50 offen offset:1024 lds
    s_mov_b32 exec_lo, 0x0fffffff
    s_mov_b32 exec_hi, 0x0fffffff
    s_add_u32 s50, s53, 28672
    s_add_u32 m0, s60, 129024
    s_nop 0
    buffer_load_dwordx4 v4, s[16:19], s50 offen lds
    s_add_u32 s50, s53, 43008
    s_add_u32 m0, s60, 130048
    s_nop 0
    buffer_load_dwordx4 v4, s[16:19], s50 offen lds
    s_mov_b64 exec, -1
    s_lshl_b32 s61, s46, 2
    s_add_u32 s61, s61, s56
    s_mul_i32 s62, s61, 28672
    s_sub_u32 s63, s62, 28672
    s_cmp_eq_u32 s61, 0
    s_cselect_b32 s63, s62, s63
    s_cselect_b32 s55, 0, -1
    s_mul_i32 s54, s45, 1792
    s_add_u32 s50, s62, s54
    s_add_u32 s50, s50, 6291456
    v_mov_b32 v26, 0
    v_mov_b32 v27, 0
    v_mov_b32 v34, 0
    v_mov_b32 v35, 0
    v_mov_b32 v42, 0
    v_mov_b32 v43, 0
    v_mov_b32 v44, 0
    v_mov_b32 v45, 0
    v_mov_b32 v46, 0
    v_mov_b32 v47, 0
    v_mov_b32 v48, 0
    v_mov_b32 v49, 0
    v_mov_b32 v50, 0
    v_mov_b32 v51, 0
    v_mov_b32 v52, 0
    v_mov_b32 v53, 0
    v_mov_b32 v54, 0
    v_mov_b32 v55, 0
    s_mov_b32 exec_lo, 0x10000000
    s_mov_b32 exec_hi, 0x10000000
    v_mov_b32 v44, 0x3f803f80
    v_mov_b32 v45, 0x3f803f80
    v_mov_b32 v46, 0x3f803f80
    v_mov_b32 v47, 0x3f803f80
    v_mov_b32 v48, 0x3f803f80
    v_mov_b32 v49, 0x3f803f80
    v_mov_b32 v50, 0x3f803f80
    v_mov_b32 v51, 0x3f803f80
    v_mov_b32 v52, 0x3f803f80
    v_mov_b32 v53, 0x3f803f80
    v_mov_b32 v54, 0x3f803f80
    v_mov_b32 v55, 0x3f803f80
    s_mov_b64 exec, -1
    buffer_load_dwordx2 v[20:21], v5, s[16:19], s50 offen offset:0
    buffer_load_dwordx2 v[22:23], v5, s[16:19], s50 offen offset:512
    buffer_load_dwordx2 v[24:25], v5, s[16:19], s50 offen offset:1024
    s_mov_b32 exec_hi, 0
    buffer_load_dwordx2 v[26:27], v5, s[16:19], s50 offen offset:1536
    s_mov_b32 exec_hi, -1
    s_add_u32 s50, s50, 2097152
    buffer_load_dwordx2 v[28:29], v5, s[16:19], s50 offen offset:0
    buffer_load_dwordx2 v[30:31], v5, s[16:19], s50 offen offset:512
    buffer_load_dwordx2 v[32:33], v5, s[16:19], s50 offen offset:1024
    s_mov_b32 exec_hi, 0
    buffer_load_dwordx2 v[34:35], v5, s[16:19], s50 offen offset:1536
    s_mov_b32 exec_hi, -1
    s_add_u32 s50, s63, s54
    s_add_u32 s50, s50, 8388608
    buffer_load_dwordx2 v[36:37], v5, s[16:19], s50 offen offset:0
    buffer_load_dwordx2 v[38:39], v5, s[16:19], s50 offen offset:512
    buffer_load_dwordx2 v[40:41], v5, s[16:19], s50 offen offset:1024
    s_mov_b32 exec_hi, 0
    buffer_load_dwordx2 v[42:43], v5, s[16:19], s50 offen offset:1536
    s_mov_b32 exec_hi, -1
    s_mul_i32 s54, s45, 448
    s_add_u32 s50, s62, s54
    s_add_u32 s50, s50, 10485760
    s_add_u32 s51, s50, 14336
    s_add_u32 s52, s63, s54
    s_add_u32 s52, s52, 10500096
    s_mov_b32 exec_lo, 0x0fffffff
    s_mov_b32 exec_hi, 0x0fffffff
    buffer_load_dwordx4 v[44:47], v4, s[16:19], s50 offen
    buffer_load_dwordx4 v[48:51], v4, s[16:19], s51 offen
    buffer_load_dwordx4 v[52:55], v4, s[16:19], s52 offen
    s_mov_b64 exec, -1
    v_mov_b32 v15, 4048155338
    s_add_u32 s62, s62, 14680064
    v_and_b32 v14, 31, v0
    v_lshlrev_b32 v14, 4, v14
    v_lshrrev_b32 v13, 5, v0
    s_and_b32 s50, s45, 1
    s_cmp_eq_u32 s50, 0
    s_cselect_b32 s51, 8, 504
    s_cselect_b32 s50, 0, 1544
    v_mad_u32_u24 v14, v13, s51, v14
    v_add_u32 v14, s50, v14
    s_lshr_b32 s50, s45, 1
    s_mul_i32 s50, s50, 3584
    v_add_u32 v14, s50, v14
    s_waitcnt vmcnt(23) lgkmcnt(0)
    s_barrier
    s_add_u32 s51, s46, 6
    s_and_b32 s51, s51, 7
    s_mul_i32 s51, s51, 0
    s_mov_b32 s51, 344064
    s_add_u32 s52, s51, s58
    s_add_u32 s53, s51, s59
    s_add_u32 s50, s52, 0
    s_add_u32 m0, s60, 90112
    s_nop 0
    buffer_load_dwordx4 v1, s[16:19], s50 offen lds
    s_mov_b32 exec_hi, 0xffff
    buffer_load_dwordx4 v1, s[16:19], s50 offen offset:1024 lds
    s_mov_b32 exec_lo, 0x0fffffff
    s_mov_b32 exec_hi, 0x0fffffff
    s_add_u32 s50, s53, 0
    s_add_u32 m0, s60, 92160
    s_nop 0
    buffer_load_dwordx4 v4, s[16:19], s50 offen lds
    s_add_u32 s50, s53, 14336
    s_add_u32 m0, s60, 93184
    s_nop 0
    buffer_load_dwordx4 v4, s[16:19], s50 offen lds
    s_mov_b64 exec, -1
    s_add_u32 s50, s52, 28672
    s_add_u32 m0, s60, 94208
    s_nop 0
    buffer_load_dwordx4 v1, s[16:19], s50 offen lds
    s_mov_b32 exec_hi, 0xffff
    buffer_load_dwordx4 v1, s[16:19], s50 offen offset:1024 lds
    s_mov_b32 exec_lo, 0x0fffffff
    s_mov_b32 exec_hi, 0x0fffffff
    s_add_u32 s50, s53, 28672
    s_add_u32 m0, s60, 96256
    s_nop 0
    buffer_load_dwordx4 v4, s[16:19], s50 offen lds
    s_add_u32 s50, s53, 43008
    s_add_u32 m0, s60, 97280
    s_nop 0
    buffer_load_dwordx4 v4, s[16:19], s50 offen lds
    s_mov_b64 exec, -1
    s_waitcnt vmcnt(8)
    v_mfma_f32_32x32x16_bf16 v[64:79], v[28:31], v[20:23], 0
    v_mfma_f32_32x32x16_bf16 v[80:95], v[36:39], v[20:23], 0
    v_mfma_f32_32x32x16_bf16 v[64:79], v[32:35], v[24:27], v[64:79]
    v_mfma_f32_32x32x16_bf16 v[80:95], v[40:43], v[24:27], v[80:95]
    s_mov_b32 s50, 0x5555
    s_mov_b32 s51, 0x55550
    s_nop 8
    v_cndmask_b32 v64, v15, v64, s[50:51]
    s_mov_b32 s52, 0xaaaa
    s_mov_b32 s53, 0xaaaa0
    v_cndmask_b32 v65, v15, v65, s[52:53]
    s_mov_b32 s50, 0x15554
    s_mov_b32 s51, 0x155540
    v_cndmask_b32 v66, v15, v66, s[50:51]
    s_mov_b32 s52, 0x2aaa8
    s_mov_b32 s53, 0x2aaa80
    v_cndmask_b32 v67, v15, v67, s[52:53]
    s_mov_b32 s50, 0x555500
    s_mov_b32 s51, 0x5555000
    v_cndmask_b32 v68, v15, v68, s[50:51]
    s_mov_b32 s52, 0xaaaa00
    s_mov_b32 s53, 0xaaaa000
    v_cndmask_b32 v69, v15, v69, s[52:53]
    s_mov_b32 s50, 0x1555400
    s_mov_b32 s51, 0x15554000
    v_cndmask_b32 v70, v15, v70, s[50:51]
    s_mov_b32 s52, 0x2aaa800
    s_mov_b32 s53, 0x2aaa8000
    v_cndmask_b32 v71, v15, v71, s[52:53]
    s_mov_b32 s50, 0x55550000
    s_mov_b32 s51, 0x55500000
    v_cndmask_b32 v72, v15, v72, s[50:51]
    s_mov_b32 s52, 0xaaaa0000
    s_mov_b32 s53, 0xaaa00000
    v_cndmask_b32 v73, v15, v73, s[52:53]
    s_mov_b32 s50, 0x55540000
    s_mov_b32 s51, 0x55400000
    v_cndmask_b32 v74, v15, v74, s[50:51]
    s_mov_b32 s52, 0xaaa80000
    s_mov_b32 s53, 0xaa800000
    v_cndmask_b32 v75, v15, v75, s[52:53]
    s_mov_b32 s50, 0x55000000
    s_mov_b32 s51, 0x50000000
    v_cndmask_b32 v76, v15, v76, s[50:51]
    s_mov_b32 s52, 0xaa000000
    s_mov_b32 s53, 0xa0000000
    v_cndmask_b32 v77, v15, v77, s[52:53]
    s_mov_b32 s50, 0x54000000
    s_mov_b32 s51, 0x40000000
    v_cndmask_b32 v78, v15, v78, s[50:51]
    s_mov_b32 s52, 0xa8000000
    s_mov_b32 s53, 0x80000000
    v_cndmask_b32 v79, v15, v79, s[52:53]
    s_and_b32 s50, s55, 0x0
    s_and_b32 s51, s55, 0x5
    v_cndmask_b32 v88, v15, v88, s[50:51]
    s_and_b32 s52, s55, 0x0
    s_and_b32 s53, s55, 0xa
    v_cndmask_b32 v89, v15, v89, s[52:53]
    s_and_b32 s50, s55, 0x1
    s_and_b32 s51, s55, 0x15
    v_cndmask_b32 v90, v15, v90, s[50:51]
    s_and_b32 s52, s55, 0x2
    s_and_b32 s53, s55, 0x2a
    v_cndmask_b32 v91, v15, v91, s[52:53]
    s_and_b32 s50, s55, 0x55
    s_and_b32 s51, s55, 0x555
    v_cndmask_b32 v92, v15, v92, s[50:51]
    s_and_b32 s52, s55, 0xaa
    s_and_b32 s53, s55, 0xaaa
    v_cndmask_b32 v93, v15, v93, s[52:53]
    s_and_b32 s50, s55, 0x155
    s_and_b32 s51, s55, 0x1555
    v_cndmask_b32 v94, v15, v94, s[50:51]
    s_and_b32 s52, s55, 0x2aa
    s_and_b32 s53, s55, 0x2aaa
    v_cndmask_b32 v95, v15, v95, s[52:53]
    v_max3_f32 v104, v64, v65, v66
    v_max3_f32 v104, v104, v67, v68
    v_max3_f32 v104, v104, v69, v70
    v_max3_f32 v104, v104, v71, v72
    v_max3_f32 v104, v104, v73, v74
    v_max_f32 v104, v104, v75
    v_max3_f32 v105, v76, v77, v78
    v_max3_f32 v105, v105, v79, v88
    v_max3_f32 v105, v105, v89, v90
    v_max3_f32 v105, v105, v91, v92
    v_max3_f32 v105, v105, v93, v94
    v_max_f32 v105, v105, v95
    v_max_f32 v104, v104, v105
    v_mov_b32 v105, v104
    s_nop 1
    v_permlane32_swap_b32 v104, v105
    v_max_f32 v104, v104, v105
    v_sub_f32 v64, v64, v104
    v_sub_f32 v65, v65, v104
    v_sub_f32 v66, v66, v104
    v_sub_f32 v67, v67, v104
    v_sub_f32 v68, v68, v104
    v_sub_f32 v69, v69, v104
    v_sub_f32 v70, v70, v104
    v_sub_f32 v71, v71, v104
    v_sub_f32 v72, v72, v104
    v_sub_f32 v73, v73, v104
    v_sub_f32 v74, v74, v104
    v_sub_f32 v75, v75, v104
    v_sub_f32 v76, v76, v104
    v_sub_f32 v77, v77, v104
    v_sub_f32 v78, v78, v104
    v_sub_f32 v79, v79, v104
    v_sub_f32 v88, v88, v104
    v_sub_f32 v89, v89, v104
    v_sub_f32 v90, v90, v104
    v_sub_f32 v91, v91, v104
    v_sub_f32 v92, v92, v104
    v_sub_f32 v93, v93, v104
    v_sub_f32 v94, v94, v104
    v_sub_f32 v95, v95, v104
    v_exp_f32 v64, v64
    v_exp_f32 v65, v65
    v_exp_f32 v66, v66
    v_exp_f32 v67, v67
    v_exp_f32 v68, v68
    v_exp_f32 v69, v69
    v_exp_f32 v70, v70
    v_exp_f32 v71, v71
    v_exp_f32 v72, v72
    v_exp_f32 v73, v73
    v_exp_f32 v74, v74
    v_exp_f32 v75, v75
    v_exp_f32 v76, v76
    v_exp_f32 v77, v77
    v_exp_f32 v78, v78
    v_exp_f32 v79, v79
    v_exp_f32 v88, v88
    v_exp_f32 v89, v89
    v_exp_f32 v90, v90
    v_exp_f32 v91, v91
    v_exp_f32 v92, v92
    v_exp_f32 v93, v93
    v_exp_f32 v94, v94
    v_exp_f32 v95, v95
    v_cvt_pk_bf16_f32 v96, v64, v65
    v_cvt_pk_bf16_f32 v97, v66, v67
    v_cvt_pk_bf16_f32 v98, v68, v69
    v_cvt_pk_bf16_f32 v99, v70, v71
    v_cvt_pk_bf16_f32 v100, v72, v73
    v_cvt_pk_bf16_f32 v101, v74, v75
    v_cvt_pk_bf16_f32 v102, v76, v77
    v_cvt_pk_bf16_f32 v103, v78, v79
    v_cvt_pk_bf16_f32 v108, v88, v89
    v_cvt_pk_bf16_f32 v109, v90, v91
    v_cvt_pk_bf16_f32 v110, v92, v93
    v_cvt_pk_bf16_f32 v111, v94, v95
    v_mfma_f32_32x32x16_bf16 v[124:139], v[44:47], v[96:99], 0
    v_mfma_f32_32x32x16_bf16 v[124:139], v[48:51], v[100:103], v[124:139]
    v_mfma_f32_32x32x16_bf16 v[124:139], v[52:55], v[108:111], v[124:139]
    s_nop 11
    v_mov_b32 v112, v136
    v_mov_b32 v113, v136
    s_nop 1
    v_permlane32_swap_b32 v112, v113
    v_rcp_f32 v112, v113
    s_nop 0
    v_mul_f32 v124, v112, v124
    v_mul_f32 v125, v112, v125
    v_mul_f32 v126, v112, v126
    v_mul_f32 v127, v112, v127
    v_mul_f32 v128, v112, v128
    v_mul_f32 v129, v112, v129
    v_mul_f32 v130, v112, v130
    v_mul_f32 v131, v112, v131
    v_mul_f32 v132, v112, v132
    v_mul_f32 v133, v112, v133
    v_mul_f32 v134, v112, v134
    v_mul_f32 v135, v112, v135
    v_mul_f32 v136, v112, v136
    v_mul_f32 v137, v112, v137
    v_mul_f32 v138, v112, v138
    v_mul_f32 v139, v112, v139
    v_cvt_pk_bf16_f32 v114, v124, v125
    v_cvt_pk_bf16_f32 v115, v126, v127
    v_cvt_pk_bf16_f32 v116, v128, v129
    v_cvt_pk_bf16_f32 v117, v130, v131
    v_cvt_pk_bf16_f32 v118, v132, v133
    v_cvt_pk_bf16_f32 v119, v134, v135
    v_cvt_pk_bf16_f32 v120, v136, v137
    v_cvt_pk_bf16_f32 v121, v138, v139
    buffer_store_dwordx2 v[114:115], v14, s[16:19], s62 offen offset:0 sc1
    buffer_store_dwordx2 v[116:117], v14, s[16:19], s62 offen offset:512 sc1
    buffer_store_dwordx2 v[118:119], v14, s[16:19], s62 offen offset:1024 sc1
    s_mov_b32 exec_hi, 0
    buffer_store_dwordx2 v[120:121], v14, s[16:19], s62 offen offset:1536 sc1
    s_mov_b64 exec, -1
    s_waitcnt lgkmcnt(0)
    s_barrier
    s_add_u32 s51, s46, 7
    s_and_b32 s51, s51, 7
    s_mul_i32 s51, s51, 0
    s_mov_b32 s51, 401408
    s_add_u32 s52, s51, s58
    s_add_u32 s53, s51, s59
    s_add_u32 s50, s52, 0
    s_add_u32 m0, s60, 57344
    s_nop 0
    buffer_load_dwordx4 v1, s[16:19], s50 offen lds
    s_mov_b32 exec_hi, 0xffff
    buffer_load_dwordx4 v1, s[16:19], s50 offen offset:1024 lds
    s_mov_b32 exec_lo, 0x0fffffff
    s_mov_b32 exec_hi, 0x0fffffff
    s_add_u32 s50, s53, 0
    s_add_u32 m0, s60, 59392
    s_nop 0
    buffer_load_dwordx4 v4, s[16:19], s50 offen lds
    s_add_u32 s50, s53, 14336
    s_add_u32 m0, s60, 60416
    s_nop 0
    buffer_load_dwordx4 v4, s[16:19], s50 offen lds
    s_mov_b64 exec, -1
    s_add_u32 s50, s52, 28672
    s_add_u32 m0, s60, 61440
    s_nop 0
    buffer_load_dwordx4 v1, s[16:19], s50 offen lds
    s_mov_b32 exec_hi, 0xffff
    buffer_load_dwordx4 v1, s[16:19], s50 offen offset:1024 lds
    s_mov_b32 exec_lo, 0x0fffffff
    s_mov_b32 exec_hi, 0x0fffffff
    s_add_u32 s50, s53, 28672
    s_add_u32 m0, s60, 63488
    s_nop 0
    buffer_load_dwordx4 v4, s[16:19], s50 offen lds
    s_add_u32 s50, s53, 43008
    s_add_u32 m0, s60, 64512
    s_nop 0
    buffer_load_dwordx4 v4, s[16:19], s50 offen lds
    s_mov_b64 exec, -1
    s_and_b32 s62, s56, 1
    s_lshr_b32 s63, s56, 1
    v_and_b32 v20, 3, v0
    v_lshlrev_b32 v20, 3, v20
    v_bfe_u32 v21, v0, 4, 1
    v_lshl_add_u32 v20, v21, 5, v20
    s_lshl_b32 s50, s63, 6
    v_add_u32 v20, s50, v20
    v_bfe_u32 v21, v0, 3, 1
    v_lshlrev_b32 v21, 6, v21
    v_xor_b32 v20, v20, v21
    v_bfe_u32 v21, v0, 2, 2
    v_lshl_add_u32 v21, v3, 3, v21
    v_lshl_add_u32 v20, v21, 7, v20
    s_lshl_b32 s61, s47, 1
    s_add_u32 s61, s61, s62
    s_lshl_b32 s50, s61, 7
    s_add_u32 s50, s50, 16777216
    v_lshlrev_b32 v22, 2, v2
    buffer_load_dword v23, v22, s[16:19], s50 offen
    s_mul_i32 s61, s61, 28672
    s_waitcnt vmcnt(9)
    s_barrier
    s_lshl_b32 s50, s46, 4
    s_add_u32 s50, s50, s45
    s_lshl_b32 s50, s50, 6
    s_add_u32 s50, s50, 16891904
    v_mov_b32 v12, 0
    v_mov_b32 v13, s49
    s_mov_b64 exec, 1
    s_cmp_lg_u32 s40, 4
    s_cbranch_scc1 PUB_24
    buffer_store_dword v13, v12, s[16:19], s50 offen sc1
    s_branch PUBE_25
PUB_24:
    buffer_load_dword v13, v12, s[36:39], 0 offen
PUBE_25:
    s_mov_b64 exec, -1
    s_waitcnt vmcnt(2) lgkmcnt(0)
    s_barrier
    s_waitcnt vmcnt(0)
    s_cmp_lg_u32 s40, s40
    s_cbranch_scc1 POLLD_27
    s_cmp_ge_u32 s42, 28
    s_cbranch_scc1 POLLD_27
    s_lshr_b32 s50, s47, 1
    s_lshl_b32 s50, s50, 10
    s_add_u32 s50, s50, 16891904
    s_mov_b32 s51, 0
    v_and_b32 v13, 15, v0
    v_lshlrev_b32 v13, 6, v13
POLL_26:
    buffer_load_dword v12, v13, s[16:19], s50 offen sc1
    s_waitcnt vmcnt(0)
    v_cmp_eq_u32 s[52:53], s49, v12
    s_nop 0
    s_cmp_eq_u64 s[52:53], -1
    s_cbranch_scc1 POLLD_27
    s_sleep 4
    s_add_u32 s51, s51, 1
    s_cmp_lt_u32 s51, 40000
    s_cbranch_scc1 POLL_26
POLLD_27:
    s_add_u32 s50, s61, 14680064
    buffer_load_dwordx4 v[144:147], v1, s[16:19], s50 offen offset:0
    buffer_load_dwordx4 v[148:151], v1, s[16:19], s50 offen offset:1024
    buffer_load_dwordx4 v[152:155], v1, s[16:19], s50 offen offset:2048
    buffer_load_dwordx4 v[156:159], v1, s[16:19], s50 offen offset:3072
    s_add_u32 s50, s61, 14684160
    buffer_load_dwordx4 v[160:163], v1, s[16:19], s50 offen offset:0
    buffer_load_dwordx4 v[164:167], v1, s[16:19], s50 offen offset:1024
    buffer_load_dwordx4 v[168:171], v1, s[16:19], s50 offen offset:2048
    buffer_load_dwordx4 v[172:175], v1, s[16:19], s50 offen offset:3072
    s_add_u32 s50, s61, 14688256
    buffer_load_dwordx4 v[176:179], v1, s[16:19], s50 offen offset:0
    buffer_load_dwordx4 v[180:183], v1, s[16:19], s50 offen offset:1024
    buffer_load_dwordx4 v[184:187], v1, s[16:19], s50 offen offset:2048
    buffer_load_dwordx4 v[188:191], v1, s[16:19], s50 offen offset:3072
    s_add_u32 s50, s61, 14692352
    buffer_load_dwordx4 v[192:195], v1, s[16:19], s50 offen offset:0
    buffer_load_dwordx4 v[196:199], v1, s[16:19], s50 offen offset:1024
    buffer_load_dwordx4 v[200:203], v1, s[16:19], s50 offen offset:2048
    buffer_load_dwordx4 v[204:207], v1, s[16:19], s50 offen offset:3072
    s_add_u32 s50, s61, 14696448
    buffer_load_dwordx4 v[208:211], v1, s[16:19], s50 offen offset:0
    buffer_load_dwordx4 v[212:215], v1, s[16:19], s50 offen offset:1024
    buffer_load_dwordx4 v[216:219], v1, s[16:19], s50 offen offset:2048
    buffer_load_dwordx4 v[220:223], v1, s[16:19], s50 offen offset:3072
    s_add_u32 s50, s61, 14700544
    buffer_load_dwordx4 v[224:227], v1, s[16:19], s50 offen offset:0
    buffer_load_dwordx4 v[228:231], v1, s[16:19], s50 offen offset:1024
    buffer_load_dwordx4 v[232:235], v1, s[16:19], s50 offen offset:2048
    buffer_load_dwordx4 v[236:239], v1, s[16:19], s50 offen offset:3072
    s_add_u32 s50, s61, 14704640
    buffer_load_dwordx4 v[240:243], v1, s[16:19], s50 offen offset:0
    buffer_load_dwordx4 v[244:247], v1, s[16:19], s50 offen offset:1024
    buffer_load_dwordx4 v[248:251], v1, s[16:19], s50 offen offset:2048
    buffer_load_dwordx4 v[252:255], v1, s[16:19], s50 offen offset:3072
    s_setprio 0
    s_barrier
    s_cmp_ge_u32 s42, 28
    s_cbranch_scc1 H_DONE
    ds_read_b64_tr_b16 v[32:33], v20 offset:0
    ds_read_b64_tr_b16 v[34:35], v20 offset:512
    ds_read_b64_tr_b16 v[36:37], v20 offset:2048
    ds_read_b64_tr_b16 v[38:39], v20 offset:2560
    ds_read_b64_tr_b16 v[40:41], v20 offset:4096
    ds_read_b64_tr_b16 v[42:43], v20 offset:4608
    ds_read_b64_tr_b16 v[44:45], v20 offset:6144
    ds_read_b64_tr_b16 v[46:47], v20 offset:6656
    s_waitcnt vmcnt(27) lgkmcnt(6)
    v_mfma_f32_32x32x16_bf16 v[80:95], v[32:35], v[144:147], 0
    ds_read_b64_tr_b16 v[32:33], v20 offset:8192
    ds_read_b64_tr_b16 v[34:35], v20 offset:8704
    s_waitcnt vmcnt(26) lgkmcnt(6)
    v_mfma_f32_32x32x16_bf16 v[80:95], v[36:39], v[148:151], v[80:95]
    ds_read_b64_tr_b16 v[36:37], v20 offset:10240
    ds_read_b64_tr_b16 v[38:39], v20 offset:10752
    s_waitcnt vmcnt(25) lgkmcnt(6)
    v_mfma_f32_32x32x16_bf16 v[80:95], v[40:43], v[152:155], v[80:95]
    ds_read_b64_tr_b16 v[40:41], v20 offset:12288
    ds_read_b64_tr_b16 v[42:43], v20 offset:12800
    s_waitcnt vmcnt(24) lgkmcnt(6)
    v_mfma_f32_32x32x16_bf16 v[80:95], v[44:47], v[156:159], v[80:95]
    ds_read_b64_tr_b16 v[44:45], v20 offset:14336
    ds_read_b64_tr_b16 v[46:47], v20 offset:14848
    s_waitcnt vmcnt(23) lgkmcnt(6)
    v_mfma_f32_32x32x16_bf16 v[80:95], v[32:35], v[160:163], v[80:95]
    ds_read_b64_tr_b16 v[32:33], v20 offset:16384
    ds_read_b64_tr_b16 v[34:35], v20 offset:16896
    s_waitcnt vmcnt(22) lgkmcnt(6)
    v_mfma_f32_32x32x16_bf16 v[80:95], v[36:39], v[164:167], v[80:95]
    ds_read_b64_tr_b16 v[36:37], v20 offset:18432
    ds_read_b64_tr_b16 v[38:39], v20 offset:18944
    s_waitcnt vmcnt(21) lgkmcnt(6)
    v_mfma_f32_32x32x16_bf16 v[80:95], v[40:43], v[168:171], v[80:95]
    ds_read_b64_tr_b16 v[40:41], v20 offset:20480
    ds_read_b64_tr_b16 v[42:43], v20 offset:20992
    s_waitcnt vmcnt(20) lgkmcnt(6)
    v_mfma_f32_32x32x16_bf16 v[80:95], v[44:47], v[172:175], v[80:95]
    ds_read_b64_tr_b16 v[44:45], v20 offset:22528
    ds_read_b64_tr_b16 v[46:47], v20 offset:23040
    s_waitcnt vmcnt(19) lgkmcnt(6)
    v_mfma_f32_32x32x16_bf16 v[80:95], v[32:35], v[176:179], v[80:95]
    ds_read_b64_tr_b16 v[32:33], v20 offset:24576
    ds_read_b64_tr_b16 v[34:35], v20 offset:25088
    s_waitcnt vmcnt(18) lgkmcnt(6)
    v_mfma_f32_32x32x16_bf16 v[80:95], v[36:39], v[180:183], v[80:95]
    ds_read_b64_tr_b16 v[36:37], v20 offset:26624
    ds_read_b64_tr_b16 v[38:39], v20 offset:27136
    s_waitcnt vmcnt(17) lgkmcnt(6)
    v_mfma_f32_32x32x16_bf16 v[80:95], v[40:43], v[184:187], v[80:95]
    ds_read_b64_tr_b16 v[40:41], v20 offset:28672
    ds_read_b64_tr_b16 v[42:43], v20 offset:29184
    s_waitcnt vmcnt(16) lgkmcnt(6)
    v_mfma_f32_32x32x16_bf16 v[80:95], v[44:47], v[188:191], v[80:95]
    ds_read_b64_tr_b16 v[44:45], v20 offset:30720
    ds_read_b64_tr_b16 v[46:47], v20 offset:31232
    s_waitcnt vmcnt(15) lgkmcnt(6)
    v_mfma_f32_32x32x16_bf16 v[80:95], v[32:35], v[192:195], v[80:95]
    ds_read_b64_tr_b16 v[32:33], v20 offset:32768
    ds_read_b64_tr_b16 v[34:35], v20 offset:33280
    s_waitcnt vmcnt(14) lgkmcnt(6)
    v_mfma_f32_32x32x16_bf16 v[80:95], v[36:39], v[196:199], v[80:95]
    ds_read_b64_tr_b16 v[36:37], v20 offset:34816
    ds_read_b64_tr_b16 v[38:39], v20 offset:35328
    s_waitcnt vmcnt(13) lgkmcnt(6)
    v_mfma_f32_32x32x16_bf16 v[80:95], v[40:43], v[200:203], v[80:95]
    ds_read_b64_tr_b16 v[40:41], v20 offset:36864
    ds_read_b64_tr_b16 v[42:43], v20 offset:37376
    s_waitcnt vmcnt(12) lgkmcnt(6)
    v_mfma_f32_32x32x16_bf16 v[80:95], v[44:47], v[204:207], v[80:95]
    ds_read_b64_tr_b16 v[44:45], v20 offset:38912
    ds_read_b64_tr_b16 v[46:47], v20 offset:39424
    s_waitcnt vmcnt(11) lgkmcnt(6)
    v_mfma_f32_32x32x16_bf16 v[80:95], v[32:35], v[208:211], v[80:95]
    ds_read_b64_tr_b16 v[32:33], v20 offset:40960
    ds_read_b64_tr_b16 v[34:35], v20 offset:41472
    s_waitcnt vmcnt(10) lgkmcnt(6)
    v_mfma_f32_32x32x16_bf16 v[80:95], v[36:39], v[212:215], v[80:95]
    ds_read_b64_tr_b16 v[36:37], v20 offset:43008
    ds_read_b64_tr_b16 v[38:39], v20 offset:43520
    s_waitcnt vmcnt(9) lgkmcnt(6)
    v_mfma_f32_32x32x16_bf16 v[80:95], v[40:43], v[216:219], v[80:95]
    ds_read_b64_tr_b16 v[40:41], v20 offset:45056
    ds_read_b64_tr_b16 v[42:43], v20 offset:45568
    s_waitcnt vmcnt(8) lgkmcnt(6)
    v_mfma_f32_32x32x16_bf16 v[80:95], v[44:47], v[220:223], v[80:95]
    ds_read_b64_tr_b16 v[44:45], v20 offset:47104
    ds_read_b64_tr_b16 v[46:47], v20 offset:47616
    s_waitcnt vmcnt(7) lgkmcnt(6)
    v_mfma_f32_32x32x16_bf16 v[80:95], v[32:35], v[224:227], v[80:95]
    ds_read_b64_tr_b16 v[32:33], v20 offset:49152
    ds_read_b64_tr_b16 v[34:35], v20 offset:49664
    s_waitcnt vmcnt(6) lgkmcnt(6)
    v_mfma_f32_32x32x16_bf16 v[80:95], v[36:39], v[228:231], v[80:95]
    ds_read_b64_tr_b16 v[36:37], v20 offset:51200
    ds_read_b64_tr_b16 v[38:39], v20 offset:51712
    s_waitcnt vmcnt(5) lgkmcnt(6)
    v_mfma_f32_32x32x16_bf16 v[80:95], v[40:43], v[232:235], v[80:95]
    ds_read_b64_tr_b16 v[40:41], v20 offset:53248
    ds_read_b64_tr_b16 v[42:43], v20 offset:53760
    s_waitcnt vmcnt(4) lgkmcnt(6)
    v_mfma_f32_32x32x16_bf16 v[80:95], v[44:47], v[236:239], v[80:95]
    ds_read_b64_tr_b16 v[44:45], v20 offset:55296
    ds_read_b64_tr_b16 v[46:47], v20 offset:55808
    s_waitcnt vmcnt(3) lgkmcnt(6)
    v_mfma_f32_32x32x16_bf16 v[80:95], v[32:35], v[240:243], v[80:95]
    s_waitcnt vmcnt(2) lgkmcnt(4)
    v_mfma_f32_32x32x16_bf16 v[80:95], v[36:39], v[244:247], v[80:95]
    s_waitcnt vmcnt(1) lgkmcnt(2)
    v_mfma_f32_32x32x16_bf16 v[80:95], v[40:43], v[248:251], v[80:95]
    s_waitcnt vmcnt(0) lgkmcnt(0)
    v_mfma_f32_32x32x16_bf16 v[80:95], v[44:47], v[252:255], v[80:95]
    v_mov_b32 v10, 157440
    v_mov_b32 v11, 1
    s_mov_b64 exec, 1
    ds_add_u32 v10, v11
    s_mov_b64 exec, -1
    s_mov_b32 s51, 0
HS_28:
    ds_read_b32 v11, v10
    s_add_u32 s51, s51, 1
    s_waitcnt lgkmcnt(0)
    v_readfirstlane_b32 s50, v11
    s_cmp_ge_u32 s51, 40000
    s_cbranch_scc1 HS_28_X
    s_cmp_lt_u32 s50, 8
    s_cbranch_scc1 HS_28
HS_28_X:
    v_lshrrev_b32 v10, 3, v0
    v_and_b32 v11, 7, v0
    v_bfe_u32 v12, v0, 4, 1
    v_lshlrev_b32 v12, 2, v12
    v_xor_b32 v11, v11, v12
    v_lshlrev_b32 v11, 4, v11
    s_movk_i32 s50, 896
    v_mad_u32_u24 v10, v10, s50, v11
    s_mul_i32 s51, s56, 100352
    s_lshl_b32 s50, s48, 7
    s_add_u32 s51, s51, s50
    s_mul_i32 s52, s56, 14336
    s_add_u32 s50, s51, 0
    s_add_u32 m0, s52, 0
    s_nop 0
    buffer_load_dwordx4 v10, s[20:23], s50 offen lds
    s_add_u32 s50, s51, 7168
    s_add_u32 m0, s52, 1024
    s_nop 0
    buffer_load_dwordx4 v10, s[20:23], s50 offen lds
    s_add_u32 s50, s51, 14336
    s_add_u32 m0, s52, 2048
    s_nop 0
    buffer_load_dwordx4 v10, s[20:23], s50 offen lds
    s_add_u32 s50, s51, 21504
    s_add_u32 m0, s52, 3072
    s_nop 0
    buffer_load_dwordx4 v10, s[20:23], s50 offen lds
    s_add_u32 s50, s51, 28672
    s_add_u32 m0, s52, 4096
    s_nop 0
    buffer_load_dwordx4 v10, s[20:23], s50 offen lds
    s_add_u32 s50, s51, 35840
    s_add_u32 m0, s52, 5120
    s_nop 0
    buffer_load_dwordx4 v10, s[20:23], s50 offen lds
    s_add_u32 s50, s51, 43008
    s_add_u32 m0, s52, 6144
    s_nop 0
    buffer_load_dwordx4 v10, s[20:23], s50 offen lds
    s_add_u32 s50, s51, 50176
    s_add_u32 m0, s52, 7168
    s_nop 0
    buffer_load_dwordx4 v10, s[20:23], s50 offen lds
    s_add_u32 s50, s51, 57344
    s_add_u32 m0, s52, 8192
    s_nop 0
    buffer_load_dwordx4 v10, s[20:23], s50 offen lds
    s_add_u32 s50, s51, 64512
    s_add_u32 m0, s52, 9216
    s_nop 0
    buffer_load_dwordx4 v10, s[20:23], s50 offen lds
    s_add_u32 s50, s51, 71680
    s_add_u32 m0, s52, 10240
    s_nop 0
    buffer_load_dwordx4 v10, s[20:23], s50 offen lds
    s_add_u32 s50, s51, 78848
    s_add_u32 m0, s52, 11264
    s_nop 0
    buffer_load_dwordx4 v10, s[20:23], s50 offen lds
    s_add_u32 s50, s51, 86016
    s_add_u32 m0, s52, 12288
    s_nop 0
    buffer_load_dwordx4 v10, s[20:23], s50 offen lds
    s_add_u32 s50, s51, 93184
    s_add_u32 m0, s52, 13312
    s_nop 0
    buffer_load_dwordx4 v10, s[20:23], s50 offen lds
    v_sub_f32 v24, 1.0, v23
    v_cvt_pk_bf16_f32 v24, v24, v24
    v_lshlrev_b32 v24, 16, v24
    s_lshl_b32 s50, s47, 6
    s_lshl_b32 s51, s62, 5
    s_add_u32 s50, s50, s51
    v_add_u32 v25, s50, v2
    s_movk_i32 s50, 896
    v_mul_lo_u32 v25, v25, s50
    v_lshl_add_u32 v25, v3, 4, v25
    s_lshl_b32 s50, s48, 7
    s_lshl_b32 s51, s63, 6
    s_add_u32 s50, s50, s51
    s_mov_b32 s59, s50
    v_mul_f32 v80, v24, v80
    v_mul_f32 v81, v24, v81
    v_mul_f32 v82, v24, v82
    v_mul_f32 v83, v24, v83
    v_mul_f32 v84, v24, v84
    v_mul_f32 v85, v24, v85
    v_mul_f32 v86, v24, v86
    v_mul_f32 v87, v24, v87
    v_mul_f32 v88, v24, v88
    v_mul_f32 v89, v24, v89
    v_mul_f32 v90, v24, v90
    v_mul_f32 v91, v24, v91
    v_mul_f32 v92, v24, v92
    v_mul_f32 v93, v24, v93
    v_mul_f32 v94, v24, v94
    v_mul_f32 v95, v24, v95
    s_waitcnt vmcnt(0)
    s_cmp_lg_u32 s40, 4
    s_cbranch_scc1 POLLD_30
    s_lshl_b32 s50, s47, 11
    s_add_u32 s50, s50, 16908288
    s_mov_b32 s51, 0
    v_and_b32 v13, 31, v0
    v_lshlrev_b32 v13, 6, v13
    s_mov_b32 s52, -1
    s_mov_b32 s53, 0
POLL_29:
    s_mov_b64 exec, s[52:53]
    buffer_load_dword v12, v13, s[16:19], s50 offen sc1
    s_waitcnt vmcnt(0)
    v_cmp_ne_u32 s[52:53], s49, v12
    s_mov_b64 exec, -1
    s_cmp_eq_u64 s[52:53], 0
    s_cbranch_scc1 POLLD_30
    s_sleep 2
    s_add_u32 s51, s51, 1
    s_cmp_lt_u32 s51, 40000
    s_cbranch_scc1 POLL_29
POLLD_30:
    s_barrier
    s_lshl_b32 s50, s47, 1
    s_mul_i32 s50, s50, 28672
    s_mul_i32 s51, s40, 7168
    s_add_u32 s50, s50, s51
    s_add_u32 s50, s50, 12582912
    s_add_u32 s52, s50, 4096
    s_add_u32 m0, s51, 57344
    s_nop 0
    buffer_load_dwordx4 v1, s[16:19], s50 offen offset:0 lds
    buffer_load_dwordx4 v1, s[16:19], s50 offen offset:1024 lds
    buffer_load_dwordx4 v1, s[16:19], s50 offen offset:2048 lds
    buffer_load_dwordx4 v1, s[16:19], s50 offen offset:3072 lds
    s_add_u32 m0, s51, 61440
    s_nop 0
    buffer_load_dwordx4 v1, s[16:19], s52 offen offset:0 lds
    buffer_load_dwordx4 v1, s[16:19], s52 offen offset:1024 lds
    buffer_load_dwordx4 v1, s[16:19], s52 offen offset:2048 lds
    s_mul_i32 s50, s62, 28672
    v_add_u32 v21, s50, v1
    v_add_u32 v21, 57344, v21
    s_waitcnt vmcnt(0)
    s_barrier
    ds_read_b128 v[96:99], v21 offset:0
    ds_read_b64_tr_b16 v[32:33], v20 offset:0
    ds_read_b64_tr_b16 v[34:35], v20 offset:512
    ds_read_b128 v[100:103], v21 offset:1024
    ds_read_b64_tr_b16 v[36:37], v20 offset:2048
    ds_read_b64_tr_b16 v[38:39], v20 offset:2560
    ds_read_b128 v[104:107], v21 offset:2048
    ds_read_b64_tr_b16 v[40:41], v20 offset:4096
    ds_read_b64_tr_b16 v[42:43], v20 offset:4608
    ds_read_b128 v[108:111], v21 offset:3072
    ds_read_b64_tr_b16 v[44:45], v20 offset:6144
    ds_read_b64_tr_b16 v[46:47], v20 offset:6656
    s_waitcnt lgkmcnt(9)
    v_mfma_f32_32x32x16_bf16 v[64:79], v[32:35], v[96:99], 0
    ds_read_b128 v[96:99], v21 offset:4096
    ds_read_b64_tr_b16 v[32:33], v20 offset:8192
    ds_read_b64_tr_b16 v[34:35], v20 offset:8704
    s_waitcnt lgkmcnt(9)
    v_mfma_f32_32x32x16_bf16 v[64:79], v[36:39], v[100:103], v[64:79]
    ds_read_b128 v[100:103], v21 offset:5120
    ds_read_b64_tr_b16 v[36:37], v20 offset:10240
    ds_read_b64_tr_b16 v[38:39], v20 offset:10752
    s_waitcnt lgkmcnt(9)
    v_mfma_f32_32x32x16_bf16 v[64:79], v[40:43], v[104:107], v[64:79]
    ds_read_b128 v[104:107], v21 offset:6144
    ds_read_b64_tr_b16 v[40:41], v20 offset:12288
    ds_read_b64_tr_b16 v[42:43], v20 offset:12800
    s_waitcnt lgkmcnt(9)
    v_mfma_f32_32x32x16_bf16 v[64:79], v[44:47], v[108:111], v[64:79]
    ds_read_b128 v[108:111], v21 offset:7168
    ds_read_b64_tr_b16 v[44:45], v20 offset:14336
    ds_read_b64_tr_b16 v[46:47], v20 offset:14848
    s_waitcnt lgkmcnt(9)
    v_mfma_f32_32x32x16_bf16 v[64:79], v[32:35], v[96:99], v[64:79]
    ds_read_b128 v[96:99], v21 offset:8192
    ds_read_b64_tr_b16 v[32:33], v20 offset:16384
    ds_read_b64_tr_b16 v[34:35], v20 offset:16896
    s_waitcnt lgkmcnt(9)
    v_mfma_f32_32x32x16_bf16 v[64:79], v[36:39], v[100:103], v[64:79]
    ds_read_b128 v[100:103], v21 offset:9216
    ds_read_b64_tr_b16 v[36:37], v20 offset:18432
    ds_read_b64_tr_b16 v[38:39], v20 offset:18944
    s_waitcnt lgkmcnt(9)
    v_mfma_f32_32x32x16_bf16 v[64:79], v[40:43], v[104:107], v[64:79]
    ds_read_b128 v[104:107], v21 offset:10240
    ds_read_b64_tr_b16 v[40:41], v20 offset:20480
    ds_read_b64_tr_b16 v[42:43], v20 offset:20992
    s_waitcnt lgkmcnt(9)
    v_mfma_f32_32x32x16_bf16 v[64:79], v[44:47], v[108:111], v[64:79]
    ds_read_b128 v[108:111], v21 offset:11264
    ds_read_b64_tr_b16 v[44:45], v20 offset:22528
    ds_read_b64_tr_b16 v[46:47], v20 offset:23040
    s_waitcnt lgkmcnt(9)
    v_mfma_f32_32x32x16_bf16 v[64:79], v[32:35], v[96:99], v[64:79]
    ds_read_b128 v[96:99], v21 offset:12288
    ds_read_b64_tr_b16 v[32:33], v20 offset:24576
    ds_read_b64_tr_b16 v[34:35], v20 offset:25088
    s_waitcnt lgkmcnt(9)
    v_mfma_f32_32x32x16_bf16 v[64:79], v[36:39], v[100:103], v[64:79]
    ds_read_b128 v[100:103], v21 offset:13312
    ds_read_b64_tr_b16 v[36:37], v20 offset:26624
    ds_read_b64_tr_b16 v[38:39], v20 offset:27136
    s_waitcnt lgkmcnt(9)
    v_mfma_f32_32x32x16_bf16 v[64:79], v[40:43], v[104:107], v[64:79]
    ds_read_b128 v[104:107], v21 offset:14336
    ds_read_b64_tr_b16 v[40:41], v20 offset:28672
    ds_read_b64_tr_b16 v[42:43], v20 offset:29184
    s_waitcnt lgkmcnt(9)
    v_mfma_f32_32x32x16_bf16 v[64:79], v[44:47], v[108:111], v[64:79]
    ds_read_b128 v[108:111], v21 offset:15360
    ds_read_b64_tr_b16 v[44:45], v20 offset:30720
    ds_read_b64_tr_b16 v[46:47], v20 offset:31232
    s_waitcnt lgkmcnt(9)
    v_mfma_f32_32x32x16_bf16 v[64:79], v[32:35], v[96:99], v[64:79]
    ds_read_b128 v[96:99], v21 offset:16384
    ds_read_b64_tr_b16 v[32:33], v20 offset:32768
    ds_read_b64_tr_b16 v[34:35], v20 offset:33280
    s_waitcnt lgkmcnt(9)
    v_mfma_f32_32x32x16_bf16 v[64:79], v[36:39], v[100:103], v[64:79]
    ds_read_b128 v[100:103], v21 offset:17408
    ds_read_b64_tr_b16 v[36:37], v20 offset:34816
    ds_read_b64_tr_b16 v[38:39], v20 offset:35328
    s_waitcnt lgkmcnt(9)
    v_mfma_f32_32x32x16_bf16 v[64:79], v[40:43], v[104:107], v[64:79]
    ds_read_b128 v[104:107], v21 offset:18432
    ds_read_b64_tr_b16 v[40:41], v20 offset:36864
    ds_read_b64_tr_b16 v[42:43], v20 offset:37376
    s_waitcnt lgkmcnt(9)
    v_mfma_f32_32x32x16_bf16 v[64:79], v[44:47], v[108:111], v[64:79]
    ds_read_b128 v[108:111], v21 offset:19456
    ds_read_b64_tr_b16 v[44:45], v20 offset:38912
    ds_read_b64_tr_b16 v[46:47], v20 offset:39424
    s_waitcnt lgkmcnt(9)
    v_mfma_f32_32x32x16_bf16 v[64:79], v[32:35], v[96:99], v[64:79]
    ds_read_b128 v[96:99], v21 offset:20480
    ds_read_b64_tr_b16 v[32:33], v20 offset:40960
    ds_read_b64_tr_b16 v[34:35], v20 offset:41472
    s_waitcnt lgkmcnt(9)
    v_mfma_f32_32x32x16_bf16 v[64:79], v[36:39], v[100:103], v[64:79]
    ds_read_b128 v[100:103], v21 offset:21504
    ds_read_b64_tr_b16 v[36:37], v20 offset:43008
    ds_read_b64_tr_b16 v[38:39], v20 offset:43520
    s_waitcnt lgkmcnt(9)
    v_mfma_f32_32x32x16_bf16 v[64:79], v[40:43], v[104:107], v[64:79]
    ds_read_b128 v[104:107], v21 offset:22528
    ds_read_b64_tr_b16 v[40:41], v20 offset:45056
    ds_read_b64_tr_b16 v[42:43], v20 offset:45568
    s_waitcnt lgkmcnt(9)
    v_mfma_f32_32x32x16_bf16 v[64:79], v[44:47], v[108:111], v[64:79]
    ds_read_b128 v[108:111], v21 offset:23552
    ds_read_b64_tr_b16 v[44:45], v20 offset:47104
    ds_read_b64_tr_b16 v[46:47], v20 offset:47616
    s_waitcnt lgkmcnt(9)
    v_mfma_f32_32x32x16_bf16 v[64:79], v[32:35], v[96:99], v[64:79]
    ds_read_b128 v[96:99], v21 offset:24576
    ds_read_b64_tr_b16 v[32:33], v20 offset:49152
    ds_read_b64_tr_b16 v[34:35], v20 offset:49664
    s_waitcnt lgkmcnt(9)
    v_mfma_f32_32x32x16_bf16 v[64:79], v[36:39], v[100:103], v[64:79]
    ds_read_b128 v[100:103], v21 offset:25600
    ds_read_b64_tr_b16 v[36:37], v20 offset:51200
    ds_read_b64_tr_b16 v[38:39], v20 offset:51712
    s_waitcnt lgkmcnt(9)
    v_mfma_f32_32x32x16_bf16 v[64:79], v[40:43], v[104:107], v[64:79]
    ds_read_b128 v[104:107], v21 offset:26624
    ds_read_b64_tr_b16 v[40:41], v20 offset:53248
    ds_read_b64_tr_b16 v[42:43], v20 offset:53760
    s_waitcnt lgkmcnt(9)
    v_mfma_f32_32x32x16_bf16 v[64:79], v[44:47], v[108:111], v[64:79]
    ds_read_b128 v[108:111], v21 offset:27648
    ds_read_b64_tr_b16 v[44:45], v20 offset:55296
    ds_read_b64_tr_b16 v[46:47], v20 offset:55808
    s_waitcnt lgkmcnt(9)
    v_mfma_f32_32x32x16_bf16 v[64:79], v[32:35], v[96:99], v[64:79]
    s_waitcnt lgkmcnt(6)
    v_mfma_f32_32x32x16_bf16 v[64:79], v[36:39], v[100:103], v[64:79]
    s_waitcnt lgkmcnt(3)
    v_mfma_f32_32x32x16_bf16 v[64:79], v[40:43], v[104:107], v[64:79]
    s_waitcnt lgkmcnt(0)
    v_mfma_f32_32x32x16_bf16 v[64:79], v[44:47], v[108:111], v[64:79]
    s_nop 11
    v_fma_f32 v64, v23, v64, v80
    v_fma_f32 v65, v23, v65, v81
    v_fma_f32 v66, v23, v66, v82
    v_fma_f32 v67, v23, v67, v83
    v_fma_f32 v68, v23, v68, v84
    v_fma_f32 v69, v23, v69, v85
    v_fma_f32 v70, v23, v70, v86
    v_fma_f32 v71, v23, v71, v87
    v_fma_f32 v72, v23, v72, v88
    v_fma_f32 v73, v23, v73, v89
    v_fma_f32 v74, v23, v74, v90
    v_fma_f32 v75, v23, v75, v91
    v_fma_f32 v76, v23, v76, v92
    v_fma_f32 v77, v23, v77, v93
    v_fma_f32 v78, v23, v78, v94
    v_fma_f32 v79, v23, v79, v95
    v_cvt_pk_bf16_f32 v32, v64, v65
    v_cvt_pk_bf16_f32 v33, v66, v67
    v_cvt_pk_bf16_f32 v34, v68, v69
    v_cvt_pk_bf16_f32 v35, v70, v71
    v_cvt_pk_bf16_f32 v36, v72, v73
    v_cvt_pk_bf16_f32 v37, v74, v75
    v_cvt_pk_bf16_f32 v38, v76, v77
    v_cvt_pk_bf16_f32 v39, v78, v79
    v_permlane32_swap_b32 v32, v34
    v_permlane32_swap_b32 v33, v35
    buffer_store_dwordx4 v[32:35], v25, s[28:31], s59 offen offset:0
    v_permlane32_swap_b32 v36, v38
    v_permlane32_swap_b32 v37, v39
    buffer_store_dwordx4 v[36:39], v25, s[28:31], s59 offen offset:32
H_DONE:
    s_endpgm
COMPUTE:
    s_waitcnt lgkmcnt(0)
    s_mov_b32 s4, s68
    s_and_b32 s5, s69, 0xffff
    s_mov_b32 s6, 1835008
    s_mov_b32 s7, 0x20000
    s_mov_b32 s8, s70
    s_and_b32 s9, s71, 0xffff
    s_mov_b32 s10, 1204224
    s_mov_b32 s11, 0x20000
    s_mov_b32 s20, s72
    s_and_b32 s21, s73, 0xffff
    s_mov_b32 s22, 401408
    s_mov_b32 s23, 0x20000
    s_mov_b32 s12, s76
    s_and_b32 s13, s77, 0xffff
    s_mov_b32 s14, 1204224
    s_mov_b32 s15, 0x20000
    s_mov_b32 s24, s78
    s_and_b32 s25, s79, 0xffff
    s_mov_b32 s26, 401408
    s_mov_b32 s27, 0x20000
    s_mov_b32 s36, s80
    s_and_b32 s37, s81, 0xffff
    s_mov_b32 s38, 896
    s_mov_b32 s39, 0x20000
    s_mov_b32 s28, s82
    s_and_b32 s29, s83, 0xffff
    s_mov_b32 s30, 1835008
    s_mov_b32 s31, 0x20000
    s_mov_b32 s32, s84
    s_and_b32 s33, s85, 0xffff
    s_mov_b32 s34, 256
    s_mov_b32 s35, 0x20000
    s_mov_b32 s16, s86
    s_and_b32 s17, s87, 0xffff
    s_mov_b32 s18, 16973824
    s_mov_b32 s19, 0x20000
    s_lshl_b32 s45, s41, 1
    s_and_b32 s50, s42, 1
    s_add_u32 s45, s45, s50
    s_lshr_b32 s46, s2, 4
    s_lshl_b32 s47, s41, 2
    s_and_b32 s50, s42, 3
    s_add_u32 s47, s47, s50
    s_lshr_b32 s48, s42, 2
    s_cmp_lg_u32 s3, -1
    s_cbranch_scc1 GATE_WG
    s_and_b32 s56, s40, 1
    s_lshr_b32 s57, s40, 1
    v_and_b32 v2, 31, v0
    v_lshrrev_b32 v3, 5, v0
    v_bfe_u32 v10, v0, 1, 3
    v_xor_b32 v10, v10, v3
    s_lshl_b32 s50, s56, 12
    v_lshlrev_b32 v11, 7, v2
    v_add_u32 v11, s50, v11
    v_xor_b32 v12, 0, v10
    v_lshl_add_u32 v4, v12, 4, v11
    v_xor_b32 v12, 2, v10
    v_lshl_add_u32 v5, v12, 4, v11
    v_xor_b32 v12, 4, v10
    v_lshl_add_u32 v6, v12, 4, v11
    v_xor_b32 v12, 6, v10
    v_lshl_add_u32 v7, v12, 4, v11
    v_and_b32 v11, 3, v0
    v_lshlrev_b32 v11, 3, v11
    v_bfe_u32 v12, v0, 4, 1
    v_lshl_add_u32 v11, v12, 5, v11
    s_lshl_b32 s50, s57, 6
    v_add_u32 v11, s50, v11
    v_bfe_u32 v12, v0, 3, 1
    v_lshlrev_b32 v12, 6, v12
    v_xor_b32 v11, v11, v12
    v_bfe_u32 v12, v0, 2, 2
    v_lshl_add_u32 v12, v3, 3, v12
    v_lshl_add_u32 v11, v12, 7, v11
    v_add_u32 v8, 57344, v11
    v_add_u32 v9, 106496, v11
    v_lshlrev_b32 v10, 3, v2
    v_lshl_add_u32 v10, v3, 8, v10
    v_lshlrev_b32 v11, 4, v2
    s_movk_i32 s50, 7168
    v_mad_u32_u24 v11, v3, s50, v11
    s_lshl_b32 s58, s43, 1
    s_add_u32 s58, s58, s56
    s_mul_i32 s58, s58, 28672
    s_lshl_b32 s59, s44, 12
    s_lshl_b32 s50, s57, 11
    s_add_u32 s59, s59, s50
    s_add_u32 s59, s59, s58
    s_lshl_b32 s60, s44, 10
    s_lshl_b32 s50, s57, 9
    s_add_u32 s60, s60, s50
    s_add_u32 s60, s60, s58
    s_mov_b32 s61, 1049335798
    s_barrier
    ds_read_b128 v[16:19], v4 offset:0
    ds_read_b64_tr_b16 v[20:21], v8 offset:0
    ds_read_b64_tr_b16 v[22:23], v8 offset:512
    ds_read_b64_tr_b16 v[24:25], v8 offset:8192
    ds_read_b64_tr_b16 v[26:27], v8 offset:8704
    ds_read_b128 v[32:35], v5 offset:0
    ds_read_b64_tr_b16 v[36:37], v8 offset:2048
    ds_read_b64_tr_b16 v[38:39], v8 offset:2560
    ds_read_b64_tr_b16 v[40:41], v8 offset:10240
    ds_read_b64_tr_b16 v[42:43], v8 offset:10752
    ds_read_b128 v[48:51], v6 offset:0
    ds_read_b64_tr_b16 v[52:53], v8 offset:4096
    ds_read_b64_tr_b16 v[54:55], v8 offset:4608
    ds_read_b64_tr_b16 v[56:57], v8 offset:12288
    ds_read_b64_tr_b16 v[58:59], v8 offset:12800
    s_waitcnt lgkmcnt(10)
    v_mfma_f32_32x32x16_bf16 v[96:111], v[20:23], v[16:19], 0
    v_mfma_f32_32x32x16_bf16 v[112:127], v[16:19], v[24:27], 0
    ds_read_b128 v[64:67], v7 offset:0
    ds_read_b64_tr_b16 v[68:69], v8 offset:6144
    ds_read_b64_tr_b16 v[70:71], v8 offset:6656
    ds_read_b64_tr_b16 v[72:73], v8 offset:14336
    ds_read_b64_tr_b16 v[74:75], v8 offset:14848
    s_waitcnt lgkmcnt(10)
    v_mfma_f32_32x32x16_bf16 v[96:111], v[36:39], v[32:35], v[96:111]
    v_mfma_f32_32x32x16_bf16 v[112:127], v[32:35], v[40:43], v[112:127]
    s_barrier
    ds_read_b128 v[16:19], v4 offset:8192
    ds_read_b64_tr_b16 v[20:21], v8 offset:16384
    ds_read_b64_tr_b16 v[22:23], v8 offset:16896
    ds_read_b64_tr_b16 v[24:25], v8 offset:24576
    ds_read_b64_tr_b16 v[26:27], v8 offset:25088
    s_waitcnt lgkmcnt(10)
    v_mfma_f32_32x32x16_bf16 v[96:111], v[52:55], v[48:51], v[96:111]
    v_mfma_f32_32x32x16_bf16 v[112:127], v[48:51], v[56:59], v[112:127]
    ds_read_b128 v[32:35], v5 offset:8192
    ds_read_b64_tr_b16 v[36:37], v8 offset:18432
    ds_read_b64_tr_b16 v[38:39], v8 offset:18944
    ds_read_b64_tr_b16 v[40:41], v8 offset:26624
    ds_read_b64_tr_b16 v[42:43], v8 offset:27136
    s_waitcnt lgkmcnt(10)
    v_mfma_f32_32x32x16_bf16 v[96:111], v[68:71], v[64:67], v[96:111]
    v_mfma_f32_32x32x16_bf16 v[112:127], v[64:67], v[72:75], v[112:127]
    ds_read_b128 v[48:51], v6 offset:8192
    ds_read_b64_tr_b16 v[52:53], v8 offset:20480
    ds_read_b64_tr_b16 v[54:55], v8 offset:20992
    ds_read_b64_tr_b16 v[56:57], v8 offset:28672
    ds_read_b64_tr_b16 v[58:59], v8 offset:29184
    s_waitcnt lgkmcnt(10)
    v_mfma_f32_32x32x16_bf16 v[96:111], v[20:23], v[16:19], v[96:111]
    v_mfma_f32_32x32x16_bf16 v[112:127], v[16:19], v[24:27], v[112:127]
    ds_read_b128 v[64:67], v7 offset:8192
    ds_read_b64_tr_b16 v[68:69], v8 offset:22528
    ds_read_b64_tr_b16 v[70:71], v8 offset:23040
    ds_read_b64_tr_b16 v[72:73], v8 offset:30720
    ds_read_b64_tr_b16 v[74:75], v8 offset:31232
    s_waitcnt lgkmcnt(10)
    v_mfma_f32_32x32x16_bf16 v[96:111], v[36:39], v[32:35], v[96:111]
    v_mfma_f32_32x32x16_bf16 v[112:127], v[32:35], v[40:43], v[112:127]
    s_barrier
    ds_read_b128 v[16:19], v4 offset:16384
    ds_read_b64_tr_b16 v[20:21], v8 offset:32768
    ds_read_b64_tr_b16 v[22:23], v8 offset:33280
    ds_read_b64_tr_b16 v[24:25], v8 offset:40960
    ds_read_b64_tr_b16 v[26:27], v8 offset:41472
    s_waitcnt lgkmcnt(10)
    v_mfma_f32_32x32x16_bf16 v[96:111], v[52:55], v[48:51], v[96:111]
    v_mfma_f32_32x32x16_bf16 v[112:127], v[48:51], v[56:59], v[112:127]
    ds_read_b128 v[32:35], v5 offset:16384
    ds_read_b64_tr_b16 v[36:37], v8 offset:34816
    ds_read_b64_tr_b16 v[38:39], v8 offset:35328
    ds_read_b64_tr_b16 v[40:41], v8 offset:43008
    ds_read_b64_tr_b16 v[42:43], v8 offset:43520
    s_waitcnt lgkmcnt(10)
    v_mfma_f32_32x32x16_bf16 v[96:111], v[68:71], v[64:67], v[96:111]
    v_mfma_f32_32x32x16_bf16 v[112:127], v[64:67], v[72:75], v[112:127]
    ds_read_b128 v[48:51], v6 offset:16384
    ds_read_b64_tr_b16 v[52:53], v8 offset:36864
    ds_read_b64_tr_b16 v[54:55], v8 offset:37376
    ds_read_b64_tr_b16 v[56:57], v8 offset:45056
    ds_read_b64_tr_b16 v[58:59], v8 offset:45568
    s_waitcnt lgkmcnt(10)
    v_mfma_f32_32x32x16_bf16 v[96:111], v[20:23], v[16:19], v[96:111]
    v_mfma_f32_32x32x16_bf16 v[112:127], v[16:19], v[24:27], v[112:127]
    ds_read_b128 v[64:67], v7 offset:16384
    ds_read_b64_tr_b16 v[68:69], v8 offset:38912
    ds_read_b64_tr_b16 v[70:71], v8 offset:39424
    ds_read_b64_tr_b16 v[72:73], v8 offset:47104
    ds_read_b64_tr_b16 v[74:75], v8 offset:47616
    s_waitcnt lgkmcnt(10)
    v_mfma_f32_32x32x16_bf16 v[96:111], v[36:39], v[32:35], v[96:111]
    v_mfma_f32_32x32x16_bf16 v[112:127], v[32:35], v[40:43], v[112:127]
    s_barrier
    ds_read_b128 v[16:19], v4 offset:24576
    ds_read_b64_tr_b16 v[20:21], v9 offset:0
    ds_read_b64_tr_b16 v[22:23], v9 offset:512
    ds_read_b64_tr_b16 v[24:25], v9 offset:8192
    ds_read_b64_tr_b16 v[26:27], v9 offset:8704
    s_waitcnt lgkmcnt(10)
    v_mfma_f32_32x32x16_bf16 v[96:111], v[52:55], v[48:51], v[96:111]
    v_mfma_f32_32x32x16_bf16 v[112:127], v[48:51], v[56:59], v[112:127]
    ds_read_b128 v[32:35], v5 offset:24576
    ds_read_b64_tr_b16 v[36:37], v9 offset:2048
    ds_read_b64_tr_b16 v[38:39], v9 offset:2560
    ds_read_b64_tr_b16 v[40:41], v9 offset:10240
    ds_read_b64_tr_b16 v[42:43], v9 offset:10752
    s_waitcnt lgkmcnt(10)
    v_mfma_f32_32x32x16_bf16 v[96:111], v[68:71], v[64:67], v[96:111]
    v_mfma_f32_32x32x16_bf16 v[112:127], v[64:67], v[72:75], v[112:127]
    ds_read_b128 v[48:51], v6 offset:24576
    ds_read_b64_tr_b16 v[52:53], v9 offset:4096
    ds_read_b64_tr_b16 v[54:55], v9 offset:4608
    ds_read_b64_tr_b16 v[56:57], v9 offset:12288
    ds_read_b64_tr_b16 v[58:59], v9 offset:12800
    s_waitcnt lgkmcnt(10)
    v_mfma_f32_32x32x16_bf16 v[96:111], v[20:23], v[16:19], v[96:111]
    v_mfma_f32_32x32x16_bf16 v[112:127], v[16:19], v[24:27], v[112:127]
    ds_read_b128 v[64:67], v7 offset:24576
    ds_read_b64_tr_b16 v[68:69], v9 offset:6144
    ds_read_b64_tr_b16 v[70:71], v9 offset:6656
    ds_read_b64_tr_b16 v[72:73], v9 offset:14336
    ds_read_b64_tr_b16 v[74:75], v9 offset:14848
    s_waitcnt lgkmcnt(10)
    v_mfma_f32_32x32x16_bf16 v[96:111], v[36:39], v[32:35], v[96:111]
    v_mfma_f32_32x32x16_bf16 v[112:127], v[32:35], v[40:43], v[112:127]
    s_barrier
    ds_read_b128 v[16:19], v4 offset:32768
    ds_read_b64_tr_b16 v[20:21], v9 offset:16384
    ds_read_b64_tr_b16 v[22:23], v9 offset:16896
    ds_read_b64_tr_b16 v[24:25], v9 offset:24576
    ds_read_b64_tr_b16 v[26:27], v9 offset:25088
    s_waitcnt lgkmcnt(10)
    v_mfma_f32_32x32x16_bf16 v[96:111], v[52:55], v[48:51], v[96:111]
    v_mfma_f32_32x32x16_bf16 v[112:127], v[48:51], v[56:59], v[112:127]
    ds_read_b128 v[32:35], v5 offset:32768
    ds_read_b64_tr_b16 v[36:37], v9 offset:18432
    ds_read_b64_tr_b16 v[38:39], v9 offset:18944
    ds_read_b64_tr_b16 v[40:41], v9 offset:26624
    ds_read_b64_tr_b16 v[42:43], v9 offset:27136
    s_waitcnt lgkmcnt(10)
    v_mfma_f32_32x32x16_bf16 v[96:111], v[68:71], v[64:67], v[96:111]
    v_mfma_f32_32x32x16_bf16 v[112:127], v[64:67], v[72:75], v[112:127]
    ds_read_b128 v[48:51], v6 offset:32768
    ds_read_b64_tr_b16 v[52:53], v9 offset:20480
    ds_read_b64_tr_b16 v[54:55], v9 offset:20992
    ds_read_b64_tr_b16 v[56:57], v9 offset:28672
    ds_read_b64_tr_b16 v[58:59], v9 offset:29184
    s_waitcnt lgkmcnt(10)
    v_mfma_f32_32x32x16_bf16 v[96:111], v[20:23], v[16:19], v[96:111]
    v_mfma_f32_32x32x16_bf16 v[112:127], v[16:19], v[24:27], v[112:127]
    ds_read_b128 v[64:67], v7 offset:32768
    ds_read_b64_tr_b16 v[68:69], v9 offset:22528
    ds_read_b64_tr_b16 v[70:71], v9 offset:23040
    ds_read_b64_tr_b16 v[72:73], v9 offset:30720
    ds_read_b64_tr_b16 v[74:75], v9 offset:31232
    s_waitcnt lgkmcnt(10)
    v_mfma_f32_32x32x16_bf16 v[96:111], v[36:39], v[32:35], v[96:111]
    v_mfma_f32_32x32x16_bf16 v[112:127], v[32:35], v[40:43], v[112:127]
    s_barrier
    ds_read_b128 v[16:19], v4 offset:40960
    ds_read_b64_tr_b16 v[20:21], v9 offset:32768
    ds_read_b64_tr_b16 v[22:23], v9 offset:33280
    ds_read_b64_tr_b16 v[24:25], v9 offset:40960
    ds_read_b64_tr_b16 v[26:27], v9 offset:41472
    s_waitcnt lgkmcnt(10)
    v_mfma_f32_32x32x16_bf16 v[96:111], v[52:55], v[48:51], v[96:111]
    v_mfma_f32_32x32x16_bf16 v[112:127], v[48:51], v[56:59], v[112:127]
    ds_read_b128 v[32:35], v5 offset:40960
    ds_read_b64_tr_b16 v[36:37], v9 offset:34816
    ds_read_b64_tr_b16 v[38:39], v9 offset:35328
    ds_read_b64_tr_b16 v[40:41], v9 offset:43008
    ds_read_b64_tr_b16 v[42:43], v9 offset:43520
    s_waitcnt lgkmcnt(10)
    v_mfma_f32_32x32x16_bf16 v[96:111], v[68:71], v[64:67], v[96:111]
    v_mfma_f32_32x32x16_bf16 v[112:127], v[64:67], v[72:75], v[112:127]
    ds_read_b128 v[48:51], v6 offset:40960
    ds_read_b64_tr_b16 v[52:53], v9 offset:36864
    ds_read_b64_tr_b16 v[54:55], v9 offset:37376
    ds_read_b64_tr_b16 v[56:57], v9 offset:45056
    ds_read_b64_tr_b16 v[58:59], v9 offset:45568
    s_waitcnt lgkmcnt(10)
    v_mfma_f32_32x32x16_bf16 v[96:111], v[20:23], v[16:19], v[96:111]
    v_mfma_f32_32x32x16_bf16 v[112:127], v[16:19], v[24:27], v[112:127]
    ds_read_b128 v[64:67], v7 offset:40960
    ds_read_b64_tr_b16 v[68:69], v9 offset:38912
    ds_read_b64_tr_b16 v[70:71], v9 offset:39424
    ds_read_b64_tr_b16 v[72:73], v9 offset:47104
    ds_read_b64_tr_b16 v[74:75], v9 offset:47616
    s_waitcnt lgkmcnt(10)
    v_mfma_f32_32x32x16_bf16 v[96:111], v[36:39], v[32:35], v[96:111]
    v_mfma_f32_32x32x16_bf16 v[112:127], v[32:35], v[40:43], v[112:127]
    s_barrier
    v_mov_b32 v208, 0
    buffer_load_dword v210, v208, s[32:35], 0 offen sc1
    ds_read_b128 v[16:19], v4 offset:49152
    ds_read_b64_tr_b16 v[20:21], v8 offset:0
    ds_read_b64_tr_b16 v[22:23], v8 offset:512
    ds_read_b64_tr_b16 v[24:25], v8 offset:8192
    ds_read_b64_tr_b16 v[26:27], v8 offset:8704
    s_waitcnt lgkmcnt(10)
    v_mfma_f32_32x32x16_bf16 v[96:111], v[52:55], v[48:51], v[96:111]
    v_mfma_f32_32x32x16_bf16 v[112:127], v[48:51], v[56:59], v[112:127]
    ds_read_b128 v[32:35], v5 offset:49152
    ds_read_b64_tr_b16 v[36:37], v8 offset:2048
    ds_read_b64_tr_b16 v[38:39], v8 offset:2560
    ds_read_b64_tr_b16 v[40:41], v8 offset:10240
    ds_read_b64_tr_b16 v[42:43], v8 offset:10752
    s_waitcnt lgkmcnt(10)
    v_mfma_f32_32x32x16_bf16 v[96:111], v[68:71], v[64:67], v[96:111]
    v_mfma_f32_32x32x16_bf16 v[112:127], v[64:67], v[72:75], v[112:127]
    ds_read_b128 v[48:51], v6 offset:49152
    ds_read_b64_tr_b16 v[52:53], v8 offset:4096
    ds_read_b64_tr_b16 v[54:55], v8 offset:4608
    ds_read_b64_tr_b16 v[56:57], v8 offset:12288
    ds_read_b64_tr_b16 v[58:59], v8 offset:12800
    s_waitcnt lgkmcnt(10)
    v_mfma_f32_32x32x16_bf16 v[96:111], v[20:23], v[16:19], v[96:111]
    v_mfma_f32_32x32x16_bf16 v[112:127], v[16:19], v[24:27], v[112:127]
    ds_read_b128 v[64:67], v7 offset:49152
    ds_read_b64_tr_b16 v[68:69], v8 offset:6144
    ds_read_b64_tr_b16 v[70:71], v8 offset:6656
    ds_read_b64_tr_b16 v[72:73], v8 offset:14336
    ds_read_b64_tr_b16 v[74:75], v8 offset:14848
    s_waitcnt lgkmcnt(10)
    v_mfma_f32_32x32x16_bf16 v[96:111], v[36:39], v[32:35], v[96:111]
    v_mfma_f32_32x32x16_bf16 v[112:127], v[32:35], v[40:43], v[112:127]
    s_barrier
    ds_read_b128 v[16:19], v4 offset:0
    ds_read_b64_tr_b16 v[20:21], v8 offset:16384
    ds_read_b64_tr_b16 v[22:23], v8 offset:16896
    s_waitcnt lgkmcnt(8)
    v_mfma_f32_32x32x16_bf16 v[96:111], v[52:55], v[48:51], v[96:111]
    v_mfma_f32_32x32x16_bf16 v[112:127], v[48:51], v[56:59], v[112:127]
    ds_read_b128 v[32:35], v5 offset:0
    ds_read_b64_tr_b16 v[36:37], v8 offset:18432
    ds_read_b64_tr_b16 v[38:39], v8 offset:18944
    ds_read_b128 v[48:51], v6 offset:0
    ds_read_b64_tr_b16 v[52:53], v8 offset:20480
    ds_read_b64_tr_b16 v[54:55], v8 offset:20992
    s_waitcnt lgkmcnt(9)
    v_mfma_f32_32x32x16_bf16 v[96:111], v[68:71], v[64:67], v[96:111]
    v_mfma_f32_32x32x16_bf16 v[112:127], v[64:67], v[72:75], v[112:127]
    ds_read_b128 v[64:67], v7 offset:0
    ds_read_b64_tr_b16 v[68:69], v8 offset:22528
    ds_read_b64_tr_b16 v[70:71], v8 offset:23040
    s_waitcnt lgkmcnt(9)
    v_mfma_f32_32x32x16_bf16 v[80:95], v[20:23], v[16:19], 0
    ds_read_b128 v[16:19], v4 offset:8192
    ds_read_b64_tr_b16 v[20:21], v8 offset:24576
    ds_read_b64_tr_b16 v[22:23], v8 offset:25088
    s_waitcnt lgkmcnt(9)
    v_mfma_f32_32x32x16_bf16 v[80:95], v[36:39], v[32:35], v[80:95]
    s_nop 1
    v_cvt_pk_bf16_f32 v192, v112, v113
    v_cvt_pk_bf16_f32 v193, v114, v115
    v_cvt_pk_bf16_f32 v194, v116, v117
    v_cvt_pk_bf16_f32 v195, v118, v119
    v_cvt_pk_bf16_f32 v196, v120, v121
    v_cvt_pk_bf16_f32 v197, v122, v123
    v_cvt_pk_bf16_f32 v198, v124, v125
    v_cvt_pk_bf16_f32 v199, v126, v127
    s_add_u32 s50, s60, 4194304
    buffer_store_dwordx4 v[192:195], v11, s[16:19], s50 offen sc1
    s_add_u32 s50, s60, 4208640
    buffer_store_dwordx4 v[196:199], v11, s[16:19], s50 offen sc1
    ds_read_b128 v[32:35], v5 offset:8192
    ds_read_b64_tr_b16 v[36:37], v8 offset:26624
    ds_read_b64_tr_b16 v[38:39], v8 offset:27136
    s_waitcnt lgkmcnt(9)
    v_mfma_f32_32x32x16_bf16 v[80:95], v[52:55], v[48:51], v[80:95]
    v_cvt_pk_bf16_f32 v184, v96, v97
    v_cvt_pk_bf16_f32 v185, v98, v99
    v_cvt_pk_bf16_f32 v186, v100, v101
    v_cvt_pk_bf16_f32 v187, v102, v103
    v_cvt_pk_bf16_f32 v188, v104, v105
    v_cvt_pk_bf16_f32 v189, v106, v107
    v_cvt_pk_bf16_f32 v190, v108, v109
    v_cvt_pk_bf16_f32 v191, v110, v111
    s_add_u32 s50, s59, 2097152
    buffer_store_dwordx2 v[184:185], v10, s[16:19], s50 offen offset:0 sc1
    buffer_store_dwordx2 v[186:187], v10, s[16:19], s50 offen offset:512 sc1
    buffer_store_dwordx2 v[188:189], v10, s[16:19], s50 offen offset:1024 sc1
    ds_read_b128 v[48:51], v6 offset:8192
    ds_read_b64_tr_b16 v[52:53], v8 offset:28672
    ds_read_b64_tr_b16 v[54:55], v8 offset:29184
    s_waitcnt lgkmcnt(9)
    v_mfma_f32_32x32x16_bf16 v[80:95], v[68:71], v[64:67], v[80:95]
    buffer_store_dwordx2 v[190:191], v10, s[16:19], s50 offen offset:1536 sc1
    ds_read_b128 v[64:67], v7 offset:8192
    ds_read_b64_tr_b16 v[68:69], v8 offset:30720
    ds_read_b64_tr_b16 v[70:71], v8 offset:31232
    s_waitcnt lgkmcnt(9)
    v_mfma_f32_32x32x16_bf16 v[80:95], v[20:23], v[16:19], v[80:95]
    s_barrier
    ds_read_b128 v[16:19], v4 offset:16384
    ds_read_b64_tr_b16 v[20:21], v8 offset:32768
    ds_read_b64_tr_b16 v[22:23], v8 offset:33280
    s_waitcnt lgkmcnt(9)
    v_mfma_f32_32x32x16_bf16 v[80:95], v[36:39], v[32:35], v[80:95]
    ds_read_b128 v[32:35], v5 offset:16384
    ds_read_b64_tr_b16 v[36:37], v8 offset:34816
    ds_read_b64_tr_b16 v[38:39], v8 offset:35328
    s_waitcnt lgkmcnt(9)
    v_mfma_f32_32x32x16_bf16 v[80:95], v[52:55], v[48:51], v[80:95]
    ds_read_b128 v[48:51], v6 offset:16384
    ds_read_b64_tr_b16 v[52:53], v8 offset:36864
    ds_read_b64_tr_b16 v[54:55], v8 offset:37376
    s_waitcnt lgkmcnt(9)
    v_mfma_f32_32x32x16_bf16 v[80:95], v[68:71], v[64:67], v[80:95]
    ds_read_b128 v[64:67], v7 offset:16384
    ds_read_b64_tr_b16 v[68:69], v8 offset:38912
    ds_read_b64_tr_b16 v[70:71], v8 offset:39424
    s_waitcnt lgkmcnt(9)
    v_mfma_f32_32x32x16_bf16 v[80:95], v[20:23], v[16:19], v[80:95]
    ds_read_b128 v[16:19], v4 offset:24576
    ds_read_b64_tr_b16 v[20:21], v8 offset:40960
    ds_read_b64_tr_b16 v[22:23], v8 offset:41472
    s_waitcnt lgkmcnt(9)
    v_mfma_f32_32x32x16_bf16 v[80:95], v[36:39], v[32:35], v[80:95]
    ds_read_b128 v[32:35], v5 offset:24576
    ds_read_b64_tr_b16 v[36:37], v8 offset:43008
    ds_read_b64_tr_b16 v[38:39], v8 offset:43520
    s_waitcnt lgkmcnt(9)
    v_mfma_f32_32x32x16_bf16 v[80:95], v[52:55], v[48:51], v[80:95]
    ds_read_b128 v[48:51], v6 offset:24576
    ds_read_b64_tr_b16 v[52:53], v8 offset:45056
    ds_read_b64_tr_b16 v[54:55], v8 offset:45568
    s_waitcnt lgkmcnt(9)
    v_mfma_f32_32x32x16_bf16 v[80:95], v[68:71], v[64:67], v[80:95]
    ds_read_b128 v[64:67], v7 offset:24576
    ds_read_b64_tr_b16 v[68:69], v8 offset:47104
    ds_read_b64_tr_b16 v[70:71], v8 offset:47616
    s_waitcnt lgkmcnt(9)
    v_mfma_f32_32x32x16_bf16 v[80:95], v[20:23], v[16:19], v[80:95]
    s_barrier
    ds_read_b128 v[16:19], v4 offset:32768
    ds_read_b64_tr_b16 v[20:21], v9 offset:0
    ds_read_b64_tr_b16 v[22:23], v9 offset:512
    s_waitcnt lgkmcnt(9)
    v_mfma_f32_32x32x16_bf16 v[80:95], v[36:39], v[32:35], v[80:95]
    ds_read_b128 v[32:35], v5 offset:32768
    ds_read_b64_tr_b16 v[36:37], v9 offset:2048
    ds_read_b64_tr_b16 v[38:39], v9 offset:2560
    s_waitcnt lgkmcnt(9)
    v_mfma_f32_32x32x16_bf16 v[80:95], v[52:55], v[48:51], v[80:95]
    ds_read_b128 v[48:51], v6 offset:32768
    ds_read_b64_tr_b16 v[52:53], v9 offset:4096
    ds_read_b64_tr_b16 v[54:55], v9 offset:4608
    s_waitcnt lgkmcnt(9)
    v_mfma_f32_32x32x16_bf16 v[80:95], v[68:71], v[64:67], v[80:95]
    ds_read_b128 v[64:67], v7 offset:32768
    ds_read_b64_tr_b16 v[68:69], v9 offset:6144
    ds_read_b64_tr_b16 v[70:71], v9 offset:6656
    s_waitcnt lgkmcnt(9)
    v_mfma_f32_32x32x16_bf16 v[80:95], v[20:23], v[16:19], v[80:95]
    ds_read_b128 v[16:19], v4 offset:40960
    ds_read_b64_tr_b16 v[20:21], v9 offset:8192
    ds_read_b64_tr_b16 v[22:23], v9 offset:8704
    s_waitcnt lgkmcnt(9)
    v_mfma_f32_32x32x16_bf16 v[80:95], v[36:39], v[32:35], v[80:95]
    ds_read_b128 v[32:35], v5 offset:40960
    ds_read_b64_tr_b16 v[36:37], v9 offset:10240
    ds_read_b64_tr_b16 v[38:39], v9 offset:10752
    s_waitcnt lgkmcnt(9)
    v_mfma_f32_32x32x16_bf16 v[80:95], v[52:55], v[48:51], v[80:95]
    ds_read_b128 v[48:51], v6 offset:40960
    ds_read_b64_tr_b16 v[52:53], v9 offset:12288
    ds_read_b64_tr_b16 v[54:55], v9 offset:12800
    s_waitcnt lgkmcnt(9)
    v_mfma_f32_32x32x16_bf16 v[80:95], v[68:71], v[64:67], v[80:95]
    ds_read_b128 v[64:67], v7 offset:40960
    ds_read_b64_tr_b16 v[68:69], v9 offset:14336
    ds_read_b64_tr_b16 v[70:71], v9 offset:14848
    s_waitcnt lgkmcnt(9)
    v_mfma_f32_32x32x16_bf16 v[80:95], v[20:23], v[16:19], v[80:95]
    s_barrier
    ds_read_b128 v[16:19], v4 offset:49152
    ds_read_b64_tr_b16 v[20:21], v9 offset:16384
    ds_read_b64_tr_b16 v[22:23], v9 offset:16896
    s_waitcnt lgkmcnt(9)
    v_mfma_f32_32x32x16_bf16 v[80:95], v[36:39], v[32:35], v[80:95]
    ds_read_b128 v[32:35], v5 offset:49152
    ds_read_b64_tr_b16 v[36:37], v9 offset:18432
    ds_read_b64_tr_b16 v[38:39], v9 offset:18944
    s_waitcnt lgkmcnt(9)
    v_mfma_f32_32x32x16_bf16 v[80:95], v[52:55], v[48:51], v[80:95]
    ds_read_b128 v[48:51], v6 offset:49152
    ds_read_b64_tr_b16 v[52:53], v9 offset:20480
    ds_read_b64_tr_b16 v[54:55], v9 offset:20992
    s_waitcnt lgkmcnt(9)
    v_mfma_f32_32x32x16_bf16 v[80:95], v[68:71], v[64:67], v[80:95]
    ds_read_b128 v[64:67], v7 offset:49152
    ds_read_b64_tr_b16 v[68:69], v9 offset:22528
    ds_read_b64_tr_b16 v[70:71], v9 offset:23040
    s_waitcnt lgkmcnt(9)
    v_mfma_f32_32x32x16_bf16 v[80:95], v[20:23], v[16:19], v[80:95]
    s_waitcnt lgkmcnt(6)
    v_mfma_f32_32x32x16_bf16 v[80:95], v[36:39], v[32:35], v[80:95]
    s_barrier
    ds_read_b128 v[16:19], v4 offset:0
    ds_read_b64_tr_b16 v[20:21], v9 offset:24576
    ds_read_b64_tr_b16 v[22:23], v9 offset:25088
    ds_read_b64_tr_b16 v[24:25], v9 offset:32768
    ds_read_b64_tr_b16 v[26:27], v9 offset:33280
    ds_read_b64_tr_b16 v[28:29], v9 offset:40960
    ds_read_b64_tr_b16 v[30:31], v9 offset:41472
    s_waitcnt lgkmcnt(10)
    v_mfma_f32_32x32x16_bf16 v[80:95], v[52:55], v[48:51], v[80:95]
    s_waitcnt lgkmcnt(7)
    v_mfma_f32_32x32x16_bf16 v[80:95], v[68:71], v[64:67], v[80:95]
    ds_read_b128 v[32:35], v5 offset:0
    ds_read_b64_tr_b16 v[36:37], v9 offset:26624
    ds_read_b64_tr_b16 v[38:39], v9 offset:27136
    ds_read_b64_tr_b16 v[40:41], v9 offset:34816
    ds_read_b64_tr_b16 v[42:43], v9 offset:35328
    ds_read_b64_tr_b16 v[44:45], v9 offset:43008
    ds_read_b64_tr_b16 v[46:47], v9 offset:43520
    s_waitcnt lgkmcnt(7)
    v_mfma_f32_32x32x16_bf16 v[128:143], v[20:23], v[16:19], 0
    v_mfma_f32_32x32x16_bf16 v[144:159], v[24:27], v[16:19], 0
    v_mfma_f32_32x32x16_bf16 v[160:175], v[16:19], v[28:31], 0
    ds_read_b128 v[48:51], v6 offset:0
    ds_read_b64_tr_b16 v[52:53], v9 offset:28672
    ds_read_b64_tr_b16 v[54:55], v9 offset:29184
    ds_read_b64_tr_b16 v[56:57], v9 offset:36864
    ds_read_b64_tr_b16 v[58:59], v9 offset:37376
    ds_read_b64_tr_b16 v[60:61], v9 offset:45056
    ds_read_b64_tr_b16 v[62:63], v9 offset:45568
    s_waitcnt lgkmcnt(7)
    v_mfma_f32_32x32x16_bf16 v[128:143], v[36:39], v[32:35], v[128:143]
    v_cvt_pk_bf16_f32 v176, v80, v81
    v_cvt_pk_bf16_f32 v177, v82, v83
    v_cvt_pk_bf16_f32 v178, v84, v85
    v_cvt_pk_bf16_f32 v179, v86, v87
    v_cvt_pk_bf16_f32 v180, v88, v89
    v_cvt_pk_bf16_f32 v181, v90, v91
    v_cvt_pk_bf16_f32 v182, v92, v93
    v_cvt_pk_bf16_f32 v183, v94, v95
    v_lshlrev_b32 v80, 16, v176
    v_and_b32 v81, 0xffff0000, v176
    v_lshlrev_b32 v82, 16, v177
    v_and_b32 v83, 0xffff0000, v177
    v_mfma_f32_32x32x16_bf16 v[144:159], v[40:43], v[32:35], v[144:159]
    v_lshlrev_b32 v84, 16, v178
    v_and_b32 v85, 0xffff0000, v178
    v_lshlrev_b32 v86, 16, v179
    v_and_b32 v87, 0xffff0000, v179
    v_lshlrev_b32 v88, 16, v180
    v_and_b32 v89, 0xffff0000, v180
    v_lshlrev_b32 v90, 16, v181
    v_and_b32 v91, 0xffff0000, v181
    v_lshlrev_b32 v92, 16, v182
    v_and_b32 v93, 0xffff0000, v182
    v_lshlrev_b32 v94, 16, v183
    v_and_b32 v95, 0xffff0000, v183
    v_mfma_f32_32x32x16_bf16 v[160:175], v[32:35], v[44:47], v[160:175]
    v_mul_f32 v80, s61, v80
    v_mul_f32 v81, s61, v81
    v_mul_f32 v82, s61, v82
    v_mul_f32 v83, s61, v83
    v_mul_f32 v84, s61, v84
    v_mul_f32 v85, s61, v85
    v_mul_f32 v86, s61, v86
    v_mul_f32 v87, s61, v87
    v_mul_f32 v88, s61, v88
    v_mul_f32 v89, s61, v89
    v_mul_f32 v90, s61, v90
    v_mul_f32 v91, s61, v91
    ds_read_b128 v[64:67], v7 offset:0
    ds_read_b64_tr_b16 v[68:69], v9 offset:30720
    ds_read_b64_tr_b16 v[70:71], v9 offset:31232
    ds_read_b64_tr_b16 v[72:73], v9 offset:38912
    ds_read_b64_tr_b16 v[74:75], v9 offset:39424
    ds_read_b64_tr_b16 v[76:77], v9 offset:47104
    ds_read_b64_tr_b16 v[78:79], v9 offset:47616
    s_waitcnt lgkmcnt(7)
    v_mfma_f32_32x32x16_bf16 v[128:143], v[52:55], v[48:51], v[128:143]
    v_mul_f32 v92, s61, v92
    v_mul_f32 v93, s61, v93
    v_mul_f32 v94, s61, v94
    v_mul_f32 v95, s61, v95
    v_cvt_pk_bf16_f32 v176, v80, v81
    v_cvt_pk_bf16_f32 v177, v82, v83
    v_mfma_f32_32x32x16_bf16 v[144:159], v[56:59], v[48:51], v[144:159]
    v_cvt_pk_bf16_f32 v178, v84, v85
    v_cvt_pk_bf16_f32 v179, v86, v87
    v_cvt_pk_bf16_f32 v180, v88, v89
    v_cvt_pk_bf16_f32 v181, v90, v91
    v_cvt_pk_bf16_f32 v182, v92, v93
    v_cvt_pk_bf16_f32 v183, v94, v95
    v_mfma_f32_32x32x16_bf16 v[160:175], v[48:51], v[60:63], v[160:175]
    s_add_u32 s50, s59, 0
    buffer_store_dwordx2 v[176:177], v10, s[16:19], s50 offen offset:0 sc1
    buffer_store_dwordx2 v[178:179], v10, s[16:19], s50 offen offset:512 sc1
    buffer_store_dwordx2 v[180:181], v10, s[16:19], s50 offen offset:1024 sc1
    buffer_store_dwordx2 v[182:183], v10, s[16:19], s50 offen offset:1536 sc1
    s_barrier
    ds_read_b128 v[16:19], v4 offset:8192
    ds_read_b64_tr_b16 v[20:21], v8 offset:0
    ds_read_b64_tr_b16 v[22:23], v8 offset:512
    ds_read_b64_tr_b16 v[24:25], v8 offset:8192
    ds_read_b64_tr_b16 v[26:27], v8 offset:8704
    ds_read_b64_tr_b16 v[28:29], v8 offset:16384
    ds_read_b64_tr_b16 v[30:31], v8 offset:16896
    s_waitcnt lgkmcnt(7)
    v_mfma_f32_32x32x16_bf16 v[128:143], v[68:71], v[64:67], v[128:143]
    v_mfma_f32_32x32x16_bf16 v[144:159], v[72:75], v[64:67], v[144:159]
    v_mfma_f32_32x32x16_bf16 v[160:175], v[64:67], v[76:79], v[160:175]
    ds_read_b128 v[32:35], v5 offset:8192
    ds_read_b64_tr_b16 v[36:37], v8 offset:2048
    ds_read_b64_tr_b16 v[38:39], v8 offset:2560
    ds_read_b64_tr_b16 v[40:41], v8 offset:10240
    ds_read_b64_tr_b16 v[42:43], v8 offset:10752
    ds_read_b64_tr_b16 v[44:45], v8 offset:18432
    ds_read_b64_tr_b16 v[46:47], v8 offset:18944
    s_waitcnt lgkmcnt(7)
    v_mfma_f32_32x32x16_bf16 v[128:143], v[20:23], v[16:19], v[128:143]
    v_mfma_f32_32x32x16_bf16 v[144:159], v[24:27], v[16:19], v[144:159]
    v_mfma_f32_32x32x16_bf16 v[160:175], v[16:19], v[28:31], v[160:175]
    ds_read_b128 v[48:51], v6 offset:8192
    ds_read_b64_tr_b16 v[52:53], v8 offset:4096
    ds_read_b64_tr_b16 v[54:55], v8 offset:4608
    ds_read_b64_tr_b16 v[56:57], v8 offset:12288
    ds_read_b64_tr_b16 v[58:59], v8 offset:12800
    ds_read_b64_tr_b16 v[60:61], v8 offset:20480
    ds_read_b64_tr_b16 v[62:63], v8 offset:20992
    s_waitcnt lgkmcnt(7)
    v_mfma_f32_32x32x16_bf16 v[128:143], v[36:39], v[32:35], v[128:143]
    v_mfma_f32_32x32x16_bf16 v[144:159], v[40:43], v[32:35], v[144:159]
    v_mfma_f32_32x32x16_bf16 v[160:175], v[32:35], v[44:47], v[160:175]
    ds_read_b128 v[64:67], v7 offset:8192
    ds_read_b64_tr_b16 v[68:69], v8 offset:6144
    ds_read_b64_tr_b16 v[70:71], v8 offset:6656
    ds_read_b64_tr_b16 v[72:73], v8 offset:14336
    ds_read_b64_tr_b16 v[74:75], v8 offset:14848
    ds_read_b64_tr_b16 v[76:77], v8 offset:22528
    ds_read_b64_tr_b16 v[78:79], v8 offset:23040
    s_waitcnt lgkmcnt(7)
    v_mfma_f32_32x32x16_bf16 v[128:143], v[52:55], v[48:51], v[128:143]
    v_mfma_f32_32x32x16_bf16 v[144:159], v[56:59], v[48:51], v[144:159]
    v_mfma_f32_32x32x16_bf16 v[160:175], v[48:51], v[60:63], v[160:175]
    s_barrier
    ds_read_b128 v[16:19], v4 offset:16384
    ds_read_b64_tr_b16 v[20:21], v8 offset:24576
    ds_read_b64_tr_b16 v[22:23], v8 offset:25088
    ds_read_b64_tr_b16 v[24:25], v8 offset:32768
    ds_read_b64_tr_b16 v[26:27], v8 offset:33280
    ds_read_b64_tr_b16 v[28:29], v8 offset:40960
    ds_read_b64_tr_b16 v[30:31], v8 offset:41472
    s_waitcnt lgkmcnt(7)
    v_mfma_f32_32x32x16_bf16 v[128:143], v[68:71], v[64:67], v[128:143]
    v_mfma_f32_32x32x16_bf16 v[144:159], v[72:75], v[64:67], v[144:159]
    v_mfma_f32_32x32x16_bf16 v[160:175], v[64:67], v[76:79], v[160:175]
    ds_read_b128 v[32:35], v5 offset:16384
    ds_read_b64_tr_b16 v[36:37], v8 offset:26624
    ds_read_b64_tr_b16 v[38:39], v8 offset:27136
    ds_read_b64_tr_b16 v[40:41], v8 offset:34816
    ds_read_b64_tr_b16 v[42:43], v8 offset:35328
    ds_read_b64_tr_b16 v[44:45], v8 offset:43008
    ds_read_b64_tr_b16 v[46:47], v8 offset:43520
    s_waitcnt lgkmcnt(7)
    v_mfma_f32_32x32x16_bf16 v[128:143], v[20:23], v[16:19], v[128:143]
    v_mfma_f32_32x32x16_bf16 v[144:159], v[24:27], v[16:19], v[144:159]
    v_mfma_f32_32x32x16_bf16 v[160:175], v[16:19], v[28:31], v[160:175]
    ds_read_b128 v[48:51], v6 offset:16384
    ds_read_b64_tr_b16 v[52:53], v8 offset:28672
    ds_read_b64_tr_b16 v[54:55], v8 offset:29184
    ds_read_b64_tr_b16 v[56:57], v8 offset:36864
    ds_read_b64_tr_b16 v[58:59], v8 offset:37376
    ds_read_b64_tr_b16 v[60:61], v8 offset:45056
    ds_read_b64_tr_b16 v[62:63], v8 offset:45568
    s_waitcnt lgkmcnt(7)
    v_mfma_f32_32x32x16_bf16 v[128:143], v[36:39], v[32:35], v[128:143]
    v_mfma_f32_32x32x16_bf16 v[144:159], v[40:43], v[32:35], v[144:159]
    v_mfma_f32_32x32x16_bf16 v[160:175], v[32:35], v[44:47], v[160:175]
    ds_read_b128 v[64:67], v7 offset:16384
    ds_read_b64_tr_b16 v[68:69], v8 offset:30720
    ds_read_b64_tr_b16 v[70:71], v8 offset:31232
    ds_read_b64_tr_b16 v[72:73], v8 offset:38912
    ds_read_b64_tr_b16 v[74:75], v8 offset:39424
    ds_read_b64_tr_b16 v[76:77], v8 offset:47104
    ds_read_b64_tr_b16 v[78:79], v8 offset:47616
    s_waitcnt lgkmcnt(7)
    v_mfma_f32_32x32x16_bf16 v[128:143], v[52:55], v[48:51], v[128:143]
    v_mfma_f32_32x32x16_bf16 v[144:159], v[56:59], v[48:51], v[144:159]
    v_mfma_f32_32x32x16_bf16 v[160:175], v[48:51], v[60:63], v[160:175]
    s_waitcnt vmcnt(0)
    s_barrier
    v_readfirstlane_b32 s49, v210
    s_nop 0
    s_cmp_lg_u32 s49, 0
    s_cbranch_scc1 NOND_32
    v_mov_b32 v208, 0
    s_mov_b32 s51, 0
NON_31:
    buffer_load_dword v209, v208, s[32:35], 0 offen sc1
    s_waitcnt vmcnt(0)
    v_readfirstlane_b32 s49, v209
    s_nop 0
    s_cmp_lg_u32 s49, 0
    s_cbranch_scc1 NOND_32
    s_sleep 4
    s_add_u32 s51, s51, 1
    s_cmp_lt_u32 s51, 40000
    s_cbranch_scc1 NON_31
NOND_32:
    s_lshl_b32 s50, s2, 6
    s_add_u32 s50, s50, 16842752
    v_mov_b32 v208, 0
    v_mov_b32 v209, s49
    s_mov_b64 exec, 1
    s_cmp_lg_u32 s40, 0
    s_cbranch_scc1 PUB_33
    buffer_store_dword v209, v208, s[16:19], s50 offen sc1
PUB_33:
    s_mov_b64 exec, -1
    ds_read_b128 v[16:19], v4 offset:24576
    ds_read_b64_tr_b16 v[20:21], v9 offset:0
    ds_read_b64_tr_b16 v[22:23], v9 offset:512
    ds_read_b64_tr_b16 v[24:25], v9 offset:8192
    ds_read_b64_tr_b16 v[26:27], v9 offset:8704
    ds_read_b64_tr_b16 v[28:29], v9 offset:16384
    ds_read_b64_tr_b16 v[30:31], v9 offset:16896
    s_waitcnt lgkmcnt(7)
    v_mfma_f32_32x32x16_bf16 v[128:143], v[68:71], v[64:67], v[128:143]
    v_mfma_f32_32x32x16_bf16 v[144:159], v[72:75], v[64:67], v[144:159]
    v_mfma_f32_32x32x16_bf16 v[160:175], v[64:67], v[76:79], v[160:175]
    ds_read_b128 v[32:35], v5 offset:24576
    ds_read_b64_tr_b16 v[36:37], v9 offset:2048
    ds_read_b64_tr_b16 v[38:39], v9 offset:2560
    ds_read_b64_tr_b16 v[40:41], v9 offset:10240
    ds_read_b64_tr_b16 v[42:43], v9 offset:10752
    ds_read_b64_tr_b16 v[44:45], v9 offset:18432
    ds_read_b64_tr_b16 v[46:47], v9 offset:18944
    s_waitcnt lgkmcnt(7)
    v_mfma_f32_32x32x16_bf16 v[128:143], v[20:23], v[16:19], v[128:143]
    v_mfma_f32_32x32x16_bf16 v[144:159], v[24:27], v[16:19], v[144:159]
    v_mfma_f32_32x32x16_bf16 v[160:175], v[16:19], v[28:31], v[160:175]
    ds_read_b128 v[48:51], v6 offset:24576
    ds_read_b64_tr_b16 v[52:53], v9 offset:4096
    ds_read_b64_tr_b16 v[54:55], v9 offset:4608
    ds_read_b64_tr_b16 v[56:57], v9 offset:12288
    ds_read_b64_tr_b16 v[58:59], v9 offset:12800
    ds_read_b64_tr_b16 v[60:61], v9 offset:20480
    ds_read_b64_tr_b16 v[62:63], v9 offset:20992
    s_waitcnt lgkmcnt(7)
    v_mfma_f32_32x32x16_bf16 v[128:143], v[36:39], v[32:35], v[128:143]
    v_mfma_f32_32x32x16_bf16 v[144:159], v[40:43], v[32:35], v[144:159]
    v_mfma_f32_32x32x16_bf16 v[160:175], v[32:35], v[44:47], v[160:175]
    ds_read_b128 v[64:67], v7 offset:24576
    ds_read_b64_tr_b16 v[68:69], v9 offset:6144
    ds_read_b64_tr_b16 v[70:71], v9 offset:6656
    ds_read_b64_tr_b16 v[72:73], v9 offset:14336
    ds_read_b64_tr_b16 v[74:75], v9 offset:14848
    ds_read_b64_tr_b16 v[76:77], v9 offset:22528
    ds_read_b64_tr_b16 v[78:79], v9 offset:23040
    s_waitcnt lgkmcnt(7)
    v_mfma_f32_32x32x16_bf16 v[128:143], v[52:55], v[48:51], v[128:143]
    v_mfma_f32_32x32x16_bf16 v[144:159], v[56:59], v[48:51], v[144:159]
    v_mfma_f32_32x32x16_bf16 v[160:175], v[48:51], v[60:63], v[160:175]
    s_barrier
    ds_read_b128 v[16:19], v4 offset:32768
    ds_read_b64_tr_b16 v[20:21], v9 offset:24576
    ds_read_b64_tr_b16 v[22:23], v9 offset:25088
    ds_read_b64_tr_b16 v[24:25], v9 offset:32768
    ds_read_b64_tr_b16 v[26:27], v9 offset:33280
    ds_read_b64_tr_b16 v[28:29], v9 offset:40960
    ds_read_b64_tr_b16 v[30:31], v9 offset:41472
    s_waitcnt lgkmcnt(7)
    v_mfma_f32_32x32x16_bf16 v[128:143], v[68:71], v[64:67], v[128:143]
    v_mfma_f32_32x32x16_bf16 v[144:159], v[72:75], v[64:67], v[144:159]
    v_mfma_f32_32x32x16_bf16 v[160:175], v[64:67], v[76:79], v[160:175]
    ds_read_b128 v[32:35], v5 offset:32768
    ds_read_b64_tr_b16 v[36:37], v9 offset:26624
    ds_read_b64_tr_b16 v[38:39], v9 offset:27136
    ds_read_b64_tr_b16 v[40:41], v9 offset:34816
    ds_read_b64_tr_b16 v[42:43], v9 offset:35328
    ds_read_b64_tr_b16 v[44:45], v9 offset:43008
    ds_read_b64_tr_b16 v[46:47], v9 offset:43520
    s_waitcnt lgkmcnt(7)
    v_mfma_f32_32x32x16_bf16 v[128:143], v[20:23], v[16:19], v[128:143]
    v_mfma_f32_32x32x16_bf16 v[144:159], v[24:27], v[16:19], v[144:159]
    v_mfma_f32_32x32x16_bf16 v[160:175], v[16:19], v[28:31], v[160:175]
    ds_read_b128 v[48:51], v6 offset:32768
    ds_read_b64_tr_b16 v[52:53], v9 offset:28672
    ds_read_b64_tr_b16 v[54:55], v9 offset:29184
    ds_read_b64_tr_b16 v[56:57], v9 offset:36864
    ds_read_b64_tr_b16 v[58:59], v9 offset:37376
    ds_read_b64_tr_b16 v[60:61], v9 offset:45056
    ds_read_b64_tr_b16 v[62:63], v9 offset:45568
    s_waitcnt lgkmcnt(7)
    v_mfma_f32_32x32x16_bf16 v[128:143], v[36:39], v[32:35], v[128:143]
    v_mfma_f32_32x32x16_bf16 v[144:159], v[40:43], v[32:35], v[144:159]
    v_mfma_f32_32x32x16_bf16 v[160:175], v[32:35], v[44:47], v[160:175]
    ds_read_b128 v[64:67], v7 offset:32768
    ds_read_b64_tr_b16 v[68:69], v9 offset:30720
    ds_read_b64_tr_b16 v[70:71], v9 offset:31232
    ds_read_b64_tr_b16 v[72:73], v9 offset:38912
    ds_read_b64_tr_b16 v[74:75], v9 offset:39424
    ds_read_b64_tr_b16 v[76:77], v9 offset:47104
    ds_read_b64_tr_b16 v[78:79], v9 offset:47616
    s_waitcnt lgkmcnt(7)
    v_mfma_f32_32x32x16_bf16 v[128:143], v[52:55], v[48:51], v[128:143]
    v_mfma_f32_32x32x16_bf16 v[144:159], v[56:59], v[48:51], v[144:159]
    v_mfma_f32_32x32x16_bf16 v[160:175], v[48:51], v[60:63], v[160:175]
    s_barrier
    ds_read_b128 v[16:19], v4 offset:40960
    ds_read_b64_tr_b16 v[20:21], v8 offset:0
    ds_read_b64_tr_b16 v[22:23], v8 offset:512
    ds_read_b64_tr_b16 v[24:25], v8 offset:8192
    ds_read_b64_tr_b16 v[26:27], v8 offset:8704
    ds_read_b64_tr_b16 v[28:29], v8 offset:16384
    ds_read_b64_tr_b16 v[30:31], v8 offset:16896
    s_waitcnt lgkmcnt(7)
    v_mfma_f32_32x32x16_bf16 v[128:143], v[68:71], v[64:67], v[128:143]
    v_mfma_f32_32x32x16_bf16 v[144:159], v[72:75], v[64:67], v[144:159]
    v_mfma_f32_32x32x16_bf16 v[160:175], v[64:67], v[76:79], v[160:175]
    ds_read_b128 v[32:35], v5 offset:40960
    ds_read_b64_tr_b16 v[36:37], v8 offset:2048
    ds_read_b64_tr_b16 v[38:39], v8 offset:2560
    ds_read_b64_tr_b16 v[40:41], v8 offset:10240
    ds_read_b64_tr_b16 v[42:43], v8 offset:10752
    ds_read_b64_tr_b16 v[44:45], v8 offset:18432
    ds_read_b64_tr_b16 v[46:47], v8 offset:18944
    s_waitcnt lgkmcnt(7)
    v_mfma_f32_32x32x16_bf16 v[128:143], v[20:23], v[16:19], v[128:143]
    v_mfma_f32_32x32x16_bf16 v[144:159], v[24:27], v[16:19], v[144:159]
    v_mfma_f32_32x32x16_bf16 v[160:175], v[16:19], v[28:31], v[160:175]
    ds_read_b128 v[48:51], v6 offset:40960
    ds_read_b64_tr_b16 v[52:53], v8 offset:4096
    ds_read_b64_tr_b16 v[54:55], v8 offset:4608
    ds_read_b64_tr_b16 v[56:57], v8 offset:12288
    ds_read_b64_tr_b16 v[58:59], v8 offset:12800
    ds_read_b64_tr_b16 v[60:61], v8 offset:20480
    ds_read_b64_tr_b16 v[62:63], v8 offset:20992
    s_waitcnt lgkmcnt(7)
    v_mfma_f32_32x32x16_bf16 v[128:143], v[36:39], v[32:35], v[128:143]
    v_mfma_f32_32x32x16_bf16 v[144:159], v[40:43], v[32:35], v[144:159]
    v_mfma_f32_32x32x16_bf16 v[160:175], v[32:35], v[44:47], v[160:175]
    ds_read_b128 v[64:67], v7 offset:40960
    ds_read_b64_tr_b16 v[68:69], v8 offset:6144
    ds_read_b64_tr_b16 v[70:71], v8 offset:6656
    ds_read_b64_tr_b16 v[72:73], v8 offset:14336
    ds_read_b64_tr_b16 v[74:75], v8 offset:14848
    ds_read_b64_tr_b16 v[76:77], v8 offset:22528
    ds_read_b64_tr_b16 v[78:79], v8 offset:23040
    s_waitcnt lgkmcnt(7)
    v_mfma_f32_32x32x16_bf16 v[128:143], v[52:55], v[48:51], v[128:143]
    v_mfma_f32_32x32x16_bf16 v[144:159], v[56:59], v[48:51], v[144:159]
    v_mfma_f32_32x32x16_bf16 v[160:175], v[48:51], v[60:63], v[160:175]
    s_barrier
    ds_read_b128 v[16:19], v4 offset:49152
    ds_read_b64_tr_b16 v[20:21], v8 offset:24576
    ds_read_b64_tr_b16 v[22:23], v8 offset:25088
    ds_read_b64_tr_b16 v[24:25], v8 offset:32768
    ds_read_b64_tr_b16 v[26:27], v8 offset:33280
    ds_read_b64_tr_b16 v[28:29], v8 offset:40960
    ds_read_b64_tr_b16 v[30:31], v8 offset:41472
    s_waitcnt lgkmcnt(7)
    v_mfma_f32_32x32x16_bf16 v[128:143], v[68:71], v[64:67], v[128:143]
    v_mfma_f32_32x32x16_bf16 v[144:159], v[72:75], v[64:67], v[144:159]
    v_mfma_f32_32x32x16_bf16 v[160:175], v[64:67], v[76:79], v[160:175]
    ds_read_b128 v[32:35], v5 offset:49152
    ds_read_b64_tr_b16 v[36:37], v8 offset:26624
    ds_read_b64_tr_b16 v[38:39], v8 offset:27136
    ds_read_b64_tr_b16 v[40:41], v8 offset:34816
    ds_read_b64_tr_b16 v[42:43], v8 offset:35328
    ds_read_b64_tr_b16 v[44:45], v8 offset:43008
    ds_read_b64_tr_b16 v[46:47], v8 offset:43520
    s_waitcnt lgkmcnt(7)
    v_mfma_f32_32x32x16_bf16 v[128:143], v[20:23], v[16:19], v[128:143]
    v_mfma_f32_32x32x16_bf16 v[144:159], v[24:27], v[16:19], v[144:159]
    v_mfma_f32_32x32x16_bf16 v[160:175], v[16:19], v[28:31], v[160:175]
    ds_read_b128 v[48:51], v6 offset:49152
    ds_read_b64_tr_b16 v[52:53], v8 offset:28672
    ds_read_b64_tr_b16 v[54:55], v8 offset:29184
    ds_read_b64_tr_b16 v[56:57], v8 offset:36864
    ds_read_b64_tr_b16 v[58:59], v8 offset:37376
    ds_read_b64_tr_b16 v[60:61], v8 offset:45056
    ds_read_b64_tr_b16 v[62:63], v8 offset:45568
    s_waitcnt lgkmcnt(7)
    v_mfma_f32_32x32x16_bf16 v[128:143], v[36:39], v[32:35], v[128:143]
    v_mfma_f32_32x32x16_bf16 v[144:159], v[40:43], v[32:35], v[144:159]
    v_mfma_f32_32x32x16_bf16 v[160:175], v[32:35], v[44:47], v[160:175]
    ds_read_b128 v[64:67], v7 offset:49152
    ds_read_b64_tr_b16 v[68:69], v8 offset:30720
    ds_read_b64_tr_b16 v[70:71], v8 offset:31232
    ds_read_b64_tr_b16 v[72:73], v8 offset:38912
    ds_read_b64_tr_b16 v[74:75], v8 offset:39424
    ds_read_b64_tr_b16 v[76:77], v8 offset:47104
    ds_read_b64_tr_b16 v[78:79], v8 offset:47616
    s_waitcnt lgkmcnt(7)
    v_mfma_f32_32x32x16_bf16 v[128:143], v[52:55], v[48:51], v[128:143]
    v_mfma_f32_32x32x16_bf16 v[144:159], v[56:59], v[48:51], v[144:159]
    v_mfma_f32_32x32x16_bf16 v[160:175], v[48:51], v[60:63], v[160:175]
    s_waitcnt lgkmcnt(0)
    v_mfma_f32_32x32x16_bf16 v[128:143], v[68:71], v[64:67], v[128:143]
    v_mfma_f32_32x32x16_bf16 v[144:159], v[72:75], v[64:67], v[144:159]
    v_mfma_f32_32x32x16_bf16 v[160:175], v[64:67], v[76:79], v[160:175]
    s_nop 9
    v_cvt_pk_bf16_f32 v176, v128, v129
    v_cvt_pk_bf16_f32 v177, v130, v131
    v_cvt_pk_bf16_f32 v178, v132, v133
    v_cvt_pk_bf16_f32 v179, v134, v135
    v_cvt_pk_bf16_f32 v180, v136, v137
    v_cvt_pk_bf16_f32 v181, v138, v139
    v_cvt_pk_bf16_f32 v182, v140, v141
    v_cvt_pk_bf16_f32 v183, v142, v143
    v_lshlrev_b32 v128, 16, v176
    v_and_b32 v129, 0xffff0000, v176
    v_lshlrev_b32 v130, 16, v177
    v_and_b32 v131, 0xffff0000, v177
    v_lshlrev_b32 v132, 16, v178
    v_and_b32 v133, 0xffff0000, v178
    v_lshlrev_b32 v134, 16, v179
    v_and_b32 v135, 0xffff0000, v179
    v_lshlrev_b32 v136, 16, v180
    v_and_b32 v137, 0xffff0000, v180
    v_lshlrev_b32 v138, 16, v181
    v_and_b32 v139, 0xffff0000, v181
    v_lshlrev_b32 v140, 16, v182
    v_and_b32 v141, 0xffff0000, v182
    v_lshlrev_b32 v142, 16, v183
    v_and_b32 v143, 0xffff0000, v183
    v_mul_f32 v128, s61, v128
    v_mul_f32 v129, s61, v129
    v_mul_f32 v130, s61, v130
    v_mul_f32 v131, s61, v131
    v_mul_f32 v132, s61, v132
    v_mul_f32 v133, s61, v133
    v_mul_f32 v134, s61, v134
    v_mul_f32 v135, s61, v135
    v_mul_f32 v136, s61, v136
    v_mul_f32 v137, s61, v137
    v_mul_f32 v138, s61, v138
    v_mul_f32 v139, s61, v139
    v_mul_f32 v140, s61, v140
    v_mul_f32 v141, s61, v141
    v_mul_f32 v142, s61, v142
    v_mul_f32 v143, s61, v143
    v_cvt_pk_bf16_f32 v176, v128, v129
    v_cvt_pk_bf16_f32 v177, v130, v131
    v_cvt_pk_bf16_f32 v178, v132, v133
    v_cvt_pk_bf16_f32 v179, v134, v135
    v_cvt_pk_bf16_f32 v180, v136, v137
    v_cvt_pk_bf16_f32 v181, v138, v139
    v_cvt_pk_bf16_f32 v182, v140, v141
    v_cvt_pk_bf16_f32 v183, v142, v143
    s_add_u32 s50, s59, 6291456
    buffer_store_dwordx2 v[176:177], v10, s[16:19], s50 offen offset:0 sc1
    buffer_store_dwordx2 v[178:179], v10, s[16:19], s50 offen offset:512 sc1
    buffer_store_dwordx2 v[180:181], v10, s[16:19], s50 offen offset:1024 sc1
    buffer_store_dwordx2 v[182:183], v10, s[16:19], s50 offen offset:1536 sc1
    v_cvt_pk_bf16_f32 v184, v144, v145
    v_cvt_pk_bf16_f32 v185, v146, v147
    v_cvt_pk_bf16_f32 v186, v148, v149
    v_cvt_pk_bf16_f32 v187, v150, v151
    v_cvt_pk_bf16_f32 v188, v152, v153
    v_cvt_pk_bf16_f32 v189, v154, v155
    v_cvt_pk_bf16_f32 v190, v156, v157
    v_cvt_pk_bf16_f32 v191, v158, v159
    s_add_u32 s50, s59, 8388608
    buffer_store_dwordx2 v[184:185], v10, s[16:19], s50 offen offset:0 sc1
    buffer_store_dwordx2 v[186:187], v10, s[16:19], s50 offen offset:512 sc1
    buffer_store_dwordx2 v[188:189], v10, s[16:19], s50 offen offset:1024 sc1
    buffer_store_dwordx2 v[190:191], v10, s[16:19], s50 offen offset:1536 sc1
    v_cvt_pk_bf16_f32 v192, v160, v161
    v_cvt_pk_bf16_f32 v193, v162, v163
    v_cvt_pk_bf16_f32 v194, v164, v165
    v_cvt_pk_bf16_f32 v195, v166, v167
    v_cvt_pk_bf16_f32 v196, v168, v169
    v_cvt_pk_bf16_f32 v197, v170, v171
    v_cvt_pk_bf16_f32 v198, v172, v173
    v_cvt_pk_bf16_f32 v199, v174, v175
    s_add_u32 s50, s60, 10485760
    buffer_store_dwordx4 v[192:195], v11, s[16:19], s50 offen sc1
    s_add_u32 s50, s60, 10500096
    buffer_store_dwordx4 v[196:199], v11, s[16:19], s50 offen sc1
    s_waitcnt lgkmcnt(0)
    s_barrier
ATT_C_ENTRY:
    v_and_b32 v224, 31, v0
    v_lshrrev_b32 v225, 5, v0
    v_lshlrev_b32 v224, 3, v224
    v_lshl_add_u32 v224, v225, 8, v224
    v_add_u32 v225, 155648, v224
    s_lshl_b32 s50, s40, 13
    v_add_u32 v226, s50, v224
    v_add_u32 v226, 90112, v226
    v_add_u32 v227, s50, v224
    v_add_u32 v227, 94208, v227
    v_add_u32 v228, s50, v224
    v_add_u32 v228, 57344, v228
    v_add_u32 v229, s50, v224
    v_add_u32 v229, 61440, v229
    v_add_u32 v230, s50, v224
    v_add_u32 v230, 122880, v230
    v_add_u32 v231, s50, v224
    v_add_u32 v231, 126976, v231
    v_add_u32 v232, s50, v1
    v_add_u32 v233, 124928, v232
    v_add_u32 v232, 59392, v232
    v_and_b32 v2, 31, v0
    v_lshlrev_b32 v2, 4, v2
    v_lshrrev_b32 v3, 5, v0
    s_and_b32 s50, s45, 1
    s_cmp_eq_u32 s50, 0
    s_cselect_b32 s51, 8, 504
    s_cselect_b32 s50, 0, 1544
    v_mad_u32_u24 v2, v3, s51, v2
    v_add_u32 v2, s50, v2
    s_lshr_b32 s50, s45, 1
    s_mul_i32 s50, s50, 3584
    v_add_u32 v2, s50, v2
    s_lshl_b32 s56, s46, 2
    s_add_u32 s56, s56, s40
    s_mul_i32 s56, s56, 28672
    s_add_u32 s56, s56, 12582912
    s_lshl_b32 s50, s40, 14
    v_add_u32 v234, s50, v1
    v_add_u32 v234, 90112, v234
    s_waitcnt vmcnt(0)
    s_barrier
    s_lshl_b32 s50, s2, 6
    s_add_u32 s50, s50, 16859136
    v_mov_b32 v188, 0
    v_mov_b32 v189, s49
    s_mov_b64 exec, 1
    s_cmp_lg_u32 s40, 0
    s_cbranch_scc1 PUB_35
    buffer_store_dword v189, v188, s[16:19], s50 offen sc1
PUB_35:
    s_mov_b64 exec, -1
    v_add_u32 v3, 4096, v225
    ds_read2_b64 v[192:195], v225 offset0:0 offset1:64
    ds_read2_b64 v[196:199], v225 offset0:128 offset1:192
    v_add_u32 v4, 2048, v225
    ds_read2_b64 v[200:203], v4 offset0:0 offset1:64
    v_add_u32 v4, 2048, v225
    ds_read2_b64 v[204:207], v4 offset0:128 offset1:192
    ds_read2_b64 v[208:211], v3 offset0:0 offset1:64
    ds_read2_b64 v[212:215], v3 offset0:128 offset1:192
    v_add_u32 v4, 6144, v225
    ds_read2_b64 v[216:219], v4 offset0:0 offset1:64
    v_add_u32 v4, 6144, v225
    ds_read2_b64 v[220:223], v4 offset0:128 offset1:192
    ds_read2_b64 v[16:19], v226 offset0:0 offset1:64
    ds_read2_b64 v[20:23], v226 offset0:128 offset1:192
    ds_read_b128 v[24:27], v232 offset:32768
    ds_read_b128 v[28:31], v232 offset:33792
    s_waitcnt lgkmcnt(0)
    s_mov_b32 exec_lo, 0
    v_mov_b32 v198, 0
    v_mov_b32 v199, 0
    v_mov_b32 v206, 0
    v_mov_b32 v207, 0
    v_mov_b32 v214, 0
    v_mov_b32 v215, 0
    v_mov_b32 v222, 0
    v_mov_b32 v223, 0
    s_mov_b32 exec_lo, -1
    v_mfma_f32_32x32x16_bf16 v[112:127], v[16:19], v[192:195], 0
    v_mfma_f32_32x32x16_bf16 v[112:127], v[20:23], v[196:199], v[112:127]
    v_mfma_f32_32x32x16_bf16 v[128:143], v[16:19], v[200:203], 0
    v_mfma_f32_32x32x16_bf16 v[128:143], v[20:23], v[204:207], v[128:143]
    v_mfma_f32_32x32x16_bf16 v[48:63], v[16:19], v[208:211], 0
    v_mfma_f32_32x32x16_bf16 v[48:63], v[20:23], v[212:215], v[48:63]
    v_mfma_f32_32x32x16_bf16 v[64:79], v[16:19], v[216:219], 0
    v_mfma_f32_32x32x16_bf16 v[64:79], v[20:23], v[220:223], v[64:79]
    s_nop 5
    v_max3_f32 v156, v112, v113, v114
    v_max3_f32 v156, v156, v115, v116
    v_max3_f32 v156, v156, v117, v118
    v_max_f32 v156, v156, v119
    v_max3_f32 v157, v120, v121, v122
    v_max3_f32 v157, v157, v123, v124
    v_max3_f32 v157, v157, v125, v126
    v_max_f32 v157, v157, v127
    v_max_f32 v156, v156, v157
    v_mov_b32 v157, v156
    s_nop 1
    v_permlane32_swap_b32 v156, v157
    v_max_f32 v156, v156, v157
    v_max3_f32 v158, v128, v129, v130
    v_max3_f32 v158, v158, v131, v132
    v_max3_f32 v158, v158, v133, v134
    v_max_f32 v158, v158, v135
    v_max3_f32 v159, v136, v137, v138
    v_max3_f32 v159, v159, v139, v140
    v_max3_f32 v159, v159, v141, v142
    v_max_f32 v159, v159, v143
    v_max_f32 v158, v158, v159
    v_mov_b32 v159, v158
    s_nop 1
    v_permlane32_swap_b32 v158, v159
    v_max_f32 v158, v158, v159
    v_max3_f32 v160, v48, v49, v50
    v_max3_f32 v160, v160, v51, v52
    v_max3_f32 v160, v160, v53, v54
    v_max_f32 v160, v160, v55
    v_max3_f32 v161, v56, v57, v58
    v_max3_f32 v161, v161, v59, v60
    v_max3_f32 v161, v161, v61, v62
    v_max_f32 v161, v161, v63
    v_max_f32 v160, v160, v161
    v_mov_b32 v161, v160
    s_nop 1
    v_permlane32_swap_b32 v160, v161
    v_max_f32 v160, v160, v161
    v_max3_f32 v162, v64, v65, v66
    v_max3_f32 v162, v162, v67, v68
    v_max3_f32 v162, v162, v69, v70
    v_max_f32 v162, v162, v71
    v_max3_f32 v163, v72, v73, v74
    v_max3_f32 v163, v163, v75, v76
    v_max3_f32 v163, v163, v77, v78
    v_max_f32 v163, v163, v79
    v_max_f32 v162, v162, v163
    v_mov_b32 v163, v162
    s_nop 1
    v_permlane32_swap_b32 v162, v163
    v_max_f32 v162, v162, v163
    v_add_f32 v156, 1109393408, v156
    v_add_f32 v158, 1109393408, v158
    v_add_f32 v160, 1109393408, v160
    v_add_f32 v162, 1109393408, v162
    v_cvt_pk_bf16_f32 v157, -v156, 0
    v_cvt_pk_bf16_f32 v159, -v158, 0
    v_cvt_pk_bf16_f32 v161, -v160, 0
    v_cvt_pk_bf16_f32 v163, -v162, 0
    s_mov_b32 exec_lo, 0
    v_mov_b32 v198, v157
    v_mov_b32 v206, v159
    v_mov_b32 v214, v161
    v_mov_b32 v222, v163
    s_mov_b32 exec_lo, -1
    v_lshlrev_b32 v152, 16, v157
    v_lshlrev_b32 v153, 16, v159
    v_lshlrev_b32 v154, 16, v161
    v_lshlrev_b32 v155, 16, v163
    v_mfma_f32_32x32x16_bf16 v[112:127], v[16:19], v[192:195], 0
    v_mfma_f32_32x32x16_bf16 v[112:127], v[20:23], v[196:199], v[112:127]
    s_nop 11
    v_exp_f32 v112, v112
    v_exp_f32 v113, v113
    v_mfma_f32_32x32x16_bf16 v[128:143], v[16:19], v[200:203], 0
    v_exp_f32 v114, v114
    v_exp_f32 v115, v115
    v_cvt_pk_bf16_f32 v144, v112, v113
    v_cvt_pk_bf16_f32 v145, v114, v115
    v_exp_f32 v116, v116
    v_exp_f32 v117, v117
    v_mfma_f32_32x32x16_bf16 v[128:143], v[20:23], v[204:207], v[128:143]
    v_exp_f32 v118, v118
    v_exp_f32 v119, v119
    v_cvt_pk_bf16_f32 v146, v116, v117
    v_cvt_pk_bf16_f32 v147, v118, v119
    v_exp_f32 v120, v120
    v_exp_f32 v121, v121
    v_exp_f32 v122, v122
    v_exp_f32 v123, v123
    v_cvt_pk_bf16_f32 v148, v120, v121
    v_cvt_pk_bf16_f32 v149, v122, v123
    v_exp_f32 v124, v124
    v_exp_f32 v125, v125
    v_mfma_f32_32x32x16_bf16 v[48:63], v[24:27], v[144:147], 0
    ds_read2_b64 v[32:35], v227 offset0:0 offset1:64
    v_exp_f32 v126, v126
    v_exp_f32 v127, v127
    v_cvt_pk_bf16_f32 v150, v124, v125
    v_cvt_pk_bf16_f32 v151, v126, v127
    v_exp_f32 v128, v128
    v_exp_f32 v129, v129
    v_mfma_f32_32x32x16_bf16 v[112:127], v[16:19], v[208:211], 0
    ds_read2_b64 v[36:39], v227 offset0:128 offset1:192
    v_exp_f32 v130, v130
    v_exp_f32 v131, v131
    v_cvt_pk_bf16_f32 v144, v128, v129
    v_cvt_pk_bf16_f32 v145, v130, v131
    v_exp_f32 v132, v132
    v_exp_f32 v133, v133
    v_mfma_f32_32x32x16_bf16 v[112:127], v[20:23], v[212:215], v[112:127]
    ds_read_b128 v[40:43], v232 offset:36864
    v_exp_f32 v134, v134
    v_exp_f32 v135, v135
    v_cvt_pk_bf16_f32 v146, v132, v133
    v_cvt_pk_bf16_f32 v147, v134, v135
    v_exp_f32 v136, v136
    v_exp_f32 v137, v137
    v_mfma_f32_32x32x16_bf16 v[48:63], v[28:31], v[148:151], v[48:63]
    ds_read_b128 v[44:47], v232 offset:37888
    v_exp_f32 v138, v138
    v_exp_f32 v139, v139
    v_cvt_pk_bf16_f32 v148, v136, v137
    v_cvt_pk_bf16_f32 v149, v138, v139
    v_exp_f32 v140, v140
    v_exp_f32 v141, v141
    v_mfma_f32_32x32x16_bf16 v[64:79], v[24:27], v[144:147], 0
    v_exp_f32 v142, v142
    v_exp_f32 v143, v143
    v_cvt_pk_bf16_f32 v150, v140, v141
    v_cvt_pk_bf16_f32 v151, v142, v143
    v_exp_f32 v112, v112
    v_exp_f32 v113, v113
    v_mfma_f32_32x32x16_bf16 v[128:143], v[16:19], v[216:219], 0
    v_exp_f32 v114, v114
    v_exp_f32 v115, v115
    v_cvt_pk_bf16_f32 v144, v112, v113
    v_cvt_pk_bf16_f32 v145, v114, v115
    v_exp_f32 v116, v116
    v_exp_f32 v117, v117
    v_mfma_f32_32x32x16_bf16 v[128:143], v[20:23], v[220:223], v[128:143]
    v_exp_f32 v118, v118
    v_exp_f32 v119, v119
    v_cvt_pk_bf16_f32 v146, v116, v117
    v_cvt_pk_bf16_f32 v147, v118, v119
    v_exp_f32 v120, v120
    v_exp_f32 v121, v121
    v_mfma_f32_32x32x16_bf16 v[64:79], v[28:31], v[148:151], v[64:79]
    v_exp_f32 v122, v122
    v_exp_f32 v123, v123
    v_cvt_pk_bf16_f32 v148, v120, v121
    v_cvt_pk_bf16_f32 v149, v122, v123
    v_exp_f32 v124, v124
    v_exp_f32 v125, v125
    v_mfma_f32_32x32x16_bf16 v[80:95], v[24:27], v[144:147], 0
    s_waitcnt lgkmcnt(0)
    v_exp_f32 v126, v126
    v_exp_f32 v127, v127
    v_cvt_pk_bf16_f32 v150, v124, v125
    v_cvt_pk_bf16_f32 v151, v126, v127
    v_exp_f32 v128, v128
    v_exp_f32 v129, v129
    v_mfma_f32_32x32x16_bf16 v[112:127], v[32:35], v[192:195], 0
    v_exp_f32 v130, v130
    v_exp_f32 v131, v131
    v_cvt_pk_bf16_f32 v144, v128, v129
    v_cvt_pk_bf16_f32 v145, v130, v131
    v_exp_f32 v132, v132
    v_exp_f32 v133, v133
    v_mfma_f32_32x32x16_bf16 v[112:127], v[36:39], v[196:199], v[112:127]
    v_exp_f32 v134, v134
    v_exp_f32 v135, v135
    v_cvt_pk_bf16_f32 v146, v132, v133
    v_cvt_pk_bf16_f32 v147, v134, v135
    v_exp_f32 v136, v136
    v_exp_f32 v137, v137
    v_mfma_f32_32x32x16_bf16 v[80:95], v[28:31], v[148:151], v[80:95]
    v_exp_f32 v138, v138
    v_exp_f32 v139, v139
    v_cvt_pk_bf16_f32 v148, v136, v137
    v_cvt_pk_bf16_f32 v149, v138, v139
    v_exp_f32 v140, v140
    v_exp_f32 v141, v141
    v_mfma_f32_32x32x16_bf16 v[96:111], v[24:27], v[144:147], 0
    v_exp_f32 v142, v142
    v_exp_f32 v143, v143
    v_cvt_pk_bf16_f32 v150, v140, v141
    v_cvt_pk_bf16_f32 v151, v142, v143
    v_exp_f32 v112, v112
    v_exp_f32 v113, v113
    v_mfma_f32_32x32x16_bf16 v[128:143], v[32:35], v[200:203], 0
    v_exp_f32 v114, v114
    v_exp_f32 v115, v115
    v_cvt_pk_bf16_f32 v144, v112, v113
    v_cvt_pk_bf16_f32 v145, v114, v115
    v_exp_f32 v116, v116
    v_exp_f32 v117, v117
    v_mfma_f32_32x32x16_bf16 v[128:143], v[36:39], v[204:207], v[128:143]
    v_exp_f32 v118, v118
    v_exp_f32 v119, v119
    v_cvt_pk_bf16_f32 v146, v116, v117
    v_cvt_pk_bf16_f32 v147, v118, v119
    v_exp_f32 v120, v120
    v_exp_f32 v121, v121
    v_mfma_f32_32x32x16_bf16 v[96:111], v[28:31], v[148:151], v[96:111]
    s_barrier
    v_exp_f32 v122, v122
    v_exp_f32 v123, v123
    v_cvt_pk_bf16_f32 v148, v120, v121
    v_cvt_pk_bf16_f32 v149, v122, v123
    v_exp_f32 v124, v124
    v_exp_f32 v125, v125
    v_mfma_f32_32x32x16_bf16 v[48:63], v[40:43], v[144:147], v[48:63]
    ds_read2_b64 v[16:19], v228 offset0:0 offset1:64
    v_exp_f32 v126, v126
    v_exp_f32 v127, v127
    v_cvt_pk_bf16_f32 v150, v124, v125
    v_cvt_pk_bf16_f32 v151, v126, v127
    v_exp_f32 v128, v128
    v_exp_f32 v129, v129
    v_mfma_f32_32x32x16_bf16 v[112:127], v[32:35], v[208:211], 0
    ds_read2_b64 v[20:23], v228 offset0:128 offset1:192
    v_exp_f32 v130, v130
    v_exp_f32 v131, v131
    v_cvt_pk_bf16_f32 v144, v128, v129
    v_cvt_pk_bf16_f32 v145, v130, v131
    v_exp_f32 v132, v132
    v_exp_f32 v133, v133
    v_mfma_f32_32x32x16_bf16 v[112:127], v[36:39], v[212:215], v[112:127]
    ds_read_b128 v[24:27], v232 offset:0
    v_exp_f32 v134, v134
    v_exp_f32 v135, v135
    v_cvt_pk_bf16_f32 v146, v132, v133
    v_cvt_pk_bf16_f32 v147, v134, v135
    v_exp_f32 v136, v136
    v_exp_f32 v137, v137
    v_mfma_f32_32x32x16_bf16 v[48:63], v[44:47], v[148:151], v[48:63]
    ds_read_b128 v[28:31], v232 offset:1024
    v_exp_f32 v138, v138
    v_exp_f32 v139, v139
    v_cvt_pk_bf16_f32 v148, v136, v137
    v_cvt_pk_bf16_f32 v149, v138, v139
    v_exp_f32 v140, v140
    v_exp_f32 v141, v141
    v_mfma_f32_32x32x16_bf16 v[64:79], v[40:43], v[144:147], v[64:79]
    v_exp_f32 v142, v142
    v_exp_f32 v143, v143
    v_cvt_pk_bf16_f32 v150, v140, v141
    v_cvt_pk_bf16_f32 v151, v142, v143
    v_exp_f32 v112, v112
    v_exp_f32 v113, v113
    v_mfma_f32_32x32x16_bf16 v[128:143], v[32:35], v[216:219], 0
    v_exp_f32 v114, v114
    v_exp_f32 v115, v115
    v_cvt_pk_bf16_f32 v144, v112, v113
    v_cvt_pk_bf16_f32 v145, v114, v115
    v_exp_f32 v116, v116
    v_exp_f32 v117, v117
    v_mfma_f32_32x32x16_bf16 v[128:143], v[36:39], v[220:223], v[128:143]
    v_exp_f32 v118, v118
    v_exp_f32 v119, v119
    v_cvt_pk_bf16_f32 v146, v116, v117
    v_cvt_pk_bf16_f32 v147, v118, v119
    v_exp_f32 v120, v120
    v_exp_f32 v121, v121
    v_mfma_f32_32x32x16_bf16 v[64:79], v[44:47], v[148:151], v[64:79]
    v_exp_f32 v122, v122
    v_exp_f32 v123, v123
    v_cvt_pk_bf16_f32 v148, v120, v121
    v_cvt_pk_bf16_f32 v149, v122, v123
    v_exp_f32 v124, v124
    v_exp_f32 v125, v125
    v_mfma_f32_32x32x16_bf16 v[80:95], v[40:43], v[144:147], v[80:95]
    s_waitcnt lgkmcnt(0)
    v_exp_f32 v126, v126
    v_exp_f32 v127, v127
    v_cvt_pk_bf16_f32 v150, v124, v125
    v_cvt_pk_bf16_f32 v151, v126, v127
    v_exp_f32 v128, v128
    v_exp_f32 v129, v129
    v_mfma_f32_32x32x16_bf16 v[112:127], v[16:19], v[192:195], 0
    v_exp_f32 v130, v130
    v_exp_f32 v131, v131
    v_cvt_pk_bf16_f32 v144, v128, v129
    v_cvt_pk_bf16_f32 v145, v130, v131
    v_exp_f32 v132, v132
    v_exp_f32 v133, v133
    v_mfma_f32_32x32x16_bf16 v[112:127], v[20:23], v[196:199], v[112:127]
    v_exp_f32 v134, v134
    v_exp_f32 v135, v135
    v_cvt_pk_bf16_f32 v146, v132, v133
    v_cvt_pk_bf16_f32 v147, v134, v135
    v_exp_f32 v136, v136
    v_exp_f32 v137, v137
    v_mfma_f32_32x32x16_bf16 v[80:95], v[44:47], v[148:151], v[80:95]
    v_exp_f32 v138, v138
    v_exp_f32 v139, v139
    v_cvt_pk_bf16_f32 v148, v136, v137
    v_cvt_pk_bf16_f32 v149, v138, v139
    v_exp_f32 v140, v140
    v_exp_f32 v141, v141
    v_mfma_f32_32x32x16_bf16 v[96:111], v[40:43], v[144:147], v[96:111]
    v_exp_f32 v142, v142
    v_exp_f32 v143, v143
    v_cvt_pk_bf16_f32 v150, v140, v141
    v_cvt_pk_bf16_f32 v151, v142, v143
    v_exp_f32 v112, v112
    v_exp_f32 v113, v113
    v_mfma_f32_32x32x16_bf16 v[128:143], v[16:19], v[200:203], 0
    v_exp_f32 v114, v114
    v_exp_f32 v115, v115
    v_cvt_pk_bf16_f32 v144, v112, v113
    v_cvt_pk_bf16_f32 v145, v114, v115
    v_exp_f32 v116, v116
    v_exp_f32 v117, v117
    v_mfma_f32_32x32x16_bf16 v[128:143], v[20:23], v[204:207], v[128:143]
    v_exp_f32 v118, v118
    v_exp_f32 v119, v119
    v_cvt_pk_bf16_f32 v146, v116, v117
    v_cvt_pk_bf16_f32 v147, v118, v119
    v_exp_f32 v120, v120
    v_exp_f32 v121, v121
    v_mfma_f32_32x32x16_bf16 v[96:111], v[44:47], v[148:151], v[96:111]
    v_exp_f32 v122, v122
    v_exp_f32 v123, v123
    v_cvt_pk_bf16_f32 v148, v120, v121
    v_cvt_pk_bf16_f32 v149, v122, v123
    v_exp_f32 v124, v124
    v_exp_f32 v125, v125
    v_mfma_f32_32x32x16_bf16 v[48:63], v[24:27], v[144:147], v[48:63]
    ds_read2_b64 v[32:35], v229 offset0:0 offset1:64
    v_exp_f32 v126, v126
    v_exp_f32 v127, v127
    v_cvt_pk_bf16_f32 v150, v124, v125
    v_cvt_pk_bf16_f32 v151, v126, v127
    v_exp_f32 v128, v128
    v_exp_f32 v129, v129
    v_mfma_f32_32x32x16_bf16 v[112:127], v[16:19], v[208:211], 0
    ds_read2_b64 v[36:39], v229 offset0:128 offset1:192
    v_exp_f32 v130, v130
    v_exp_f32 v131, v131
    v_cvt_pk_bf16_f32 v144, v128, v129
    v_cvt_pk_bf16_f32 v145, v130, v131
    v_exp_f32 v132, v132
    v_exp_f32 v133, v133
    v_mfma_f32_32x32x16_bf16 v[112:127], v[20:23], v[212:215], v[112:127]
    ds_read_b128 v[40:43], v232 offset:4096
    v_exp_f32 v134, v134
    v_exp_f32 v135, v135
    v_cvt_pk_bf16_f32 v146, v132, v133
    v_cvt_pk_bf16_f32 v147, v134, v135
    v_exp_f32 v136, v136
    v_exp_f32 v137, v137
    v_mfma_f32_32x32x16_bf16 v[48:63], v[28:31], v[148:151], v[48:63]
    ds_read_b128 v[44:47], v232 offset:5120
    v_exp_f32 v138, v138
    v_exp_f32 v139, v139
    v_cvt_pk_bf16_f32 v148, v136, v137
    v_cvt_pk_bf16_f32 v149, v138, v139
    v_exp_f32 v140, v140
    v_exp_f32 v141, v141
    v_mfma_f32_32x32x16_bf16 v[64:79], v[24:27], v[144:147], v[64:79]
    v_exp_f32 v142, v142
    v_exp_f32 v143, v143
    v_cvt_pk_bf16_f32 v150, v140, v141
    v_cvt_pk_bf16_f32 v151, v142, v143
    v_exp_f32 v112, v112
    v_exp_f32 v113, v113
    v_mfma_f32_32x32x16_bf16 v[128:143], v[16:19], v[216:219], 0
    v_exp_f32 v114, v114
    v_exp_f32 v115, v115
    v_cvt_pk_bf16_f32 v144, v112, v113
    v_cvt_pk_bf16_f32 v145, v114, v115
    v_exp_f32 v116, v116
    v_exp_f32 v117, v117
    v_mfma_f32_32x32x16_bf16 v[128:143], v[20:23], v[220:223], v[128:143]
    v_exp_f32 v118, v118
    v_exp_f32 v119, v119
    v_cvt_pk_bf16_f32 v146, v116, v117
    v_cvt_pk_bf16_f32 v147, v118, v119
    v_exp_f32 v120, v120
    v_exp_f32 v121, v121
    v_mfma_f32_32x32x16_bf16 v[64:79], v[28:31], v[148:151], v[64:79]
    v_exp_f32 v122, v122
    v_exp_f32 v123, v123
    v_cvt_pk_bf16_f32 v148, v120, v121
    v_cvt_pk_bf16_f32 v149, v122, v123
    v_exp_f32 v124, v124
    v_exp_f32 v125, v125
    v_mfma_f32_32x32x16_bf16 v[80:95], v[24:27], v[144:147], v[80:95]
    s_waitcnt lgkmcnt(0)
    v_exp_f32 v126, v126
    v_exp_f32 v127, v127
    v_cvt_pk_bf16_f32 v150, v124, v125
    v_cvt_pk_bf16_f32 v151, v126, v127
    v_exp_f32 v128, v128
    v_exp_f32 v129, v129
    v_mfma_f32_32x32x16_bf16 v[112:127], v[32:35], v[192:195], 0
    v_exp_f32 v130, v130
    v_exp_f32 v131, v131
    v_cvt_pk_bf16_f32 v144, v128, v129
    v_cvt_pk_bf16_f32 v145, v130, v131
    v_exp_f32 v132, v132
    v_exp_f32 v133, v133
    v_mfma_f32_32x32x16_bf16 v[112:127], v[36:39], v[196:199], v[112:127]
    v_exp_f32 v134, v134
    v_exp_f32 v135, v135
    v_cvt_pk_bf16_f32 v146, v132, v133
    v_cvt_pk_bf16_f32 v147, v134, v135
    v_exp_f32 v136, v136
    v_exp_f32 v137, v137
    v_mfma_f32_32x32x16_bf16 v[80:95], v[28:31], v[148:151], v[80:95]
    v_exp_f32 v138, v138
    v_exp_f32 v139, v139
    v_cvt_pk_bf16_f32 v148, v136, v137
    v_cvt_pk_bf16_f32 v149, v138, v139
    v_exp_f32 v140, v140
    v_exp_f32 v141, v141
    v_mfma_f32_32x32x16_bf16 v[96:111], v[24:27], v[144:147], v[96:111]
    v_exp_f32 v142, v142
    v_exp_f32 v143, v143
    v_cvt_pk_bf16_f32 v150, v140, v141
    v_cvt_pk_bf16_f32 v151, v142, v143
    v_exp_f32 v112, v112
    v_exp_f32 v113, v113
    v_mfma_f32_32x32x16_bf16 v[128:143], v[32:35], v[200:203], 0
    v_exp_f32 v114, v114
    v_exp_f32 v115, v115
    v_cvt_pk_bf16_f32 v144, v112, v113
    v_cvt_pk_bf16_f32 v145, v114, v115
    v_exp_f32 v116, v116
    v_exp_f32 v117, v117
    v_mfma_f32_32x32x16_bf16 v[128:143], v[36:39], v[204:207], v[128:143]
    v_exp_f32 v118, v118
    v_exp_f32 v119, v119
    v_cvt_pk_bf16_f32 v146, v116, v117
    v_cvt_pk_bf16_f32 v147, v118, v119
    v_exp_f32 v120, v120
    v_exp_f32 v121, v121
    v_mfma_f32_32x32x16_bf16 v[96:111], v[28:31], v[148:151], v[96:111]
    s_barrier
    v_exp_f32 v122, v122
    v_exp_f32 v123, v123
    v_cvt_pk_bf16_f32 v148, v120, v121
    v_cvt_pk_bf16_f32 v149, v122, v123
    v_exp_f32 v124, v124
    v_exp_f32 v125, v125
    v_mfma_f32_32x32x16_bf16 v[48:63], v[40:43], v[144:147], v[48:63]
    ds_read2_b64 v[16:19], v230 offset0:0 offset1:64
    v_exp_f32 v126, v126
    v_exp_f32 v127, v127
    v_cvt_pk_bf16_f32 v150, v124, v125
    v_cvt_pk_bf16_f32 v151, v126, v127
    v_exp_f32 v128, v128
    v_exp_f32 v129, v129
    v_mfma_f32_32x32x16_bf16 v[112:127], v[32:35], v[208:211], 0
    ds_read2_b64 v[20:23], v230 offset0:128 offset1:192
    v_exp_f32 v130, v130
    v_exp_f32 v131, v131
    v_cvt_pk_bf16_f32 v144, v128, v129
    v_cvt_pk_bf16_f32 v145, v130, v131
    v_exp_f32 v132, v132
    v_exp_f32 v133, v133
    v_mfma_f32_32x32x16_bf16 v[112:127], v[36:39], v[212:215], v[112:127]
    ds_read_b128 v[24:27], v233 offset:0
    v_exp_f32 v134, v134
    v_exp_f32 v135, v135
    v_cvt_pk_bf16_f32 v146, v132, v133
    v_cvt_pk_bf16_f32 v147, v134, v135
    v_exp_f32 v136, v136
    v_exp_f32 v137, v137
    v_mfma_f32_32x32x16_bf16 v[48:63], v[44:47], v[148:151], v[48:63]
    ds_read_b128 v[28:31], v233 offset:1024
    v_exp_f32 v138, v138
    v_exp_f32 v139, v139
    v_cvt_pk_bf16_f32 v148, v136, v137
    v_cvt_pk_bf16_f32 v149, v138, v139
    v_exp_f32 v140, v140
    v_exp_f32 v141, v141
    v_mfma_f32_32x32x16_bf16 v[64:79], v[40:43], v[144:147], v[64:79]
    v_exp_f32 v142, v142
    v_exp_f32 v143, v143
    v_cvt_pk_bf16_f32 v150, v140, v141
    v_cvt_pk_bf16_f32 v151, v142, v143
    v_exp_f32 v112, v112
    v_exp_f32 v113, v113
    v_mfma_f32_32x32x16_bf16 v[128:143], v[32:35], v[216:219], 0
    v_exp_f32 v114, v114
    v_exp_f32 v115, v115
    v_cvt_pk_bf16_f32 v144, v112, v113
    v_cvt_pk_bf16_f32 v145, v114, v115
    v_exp_f32 v116, v116
    v_exp_f32 v117, v117
    v_mfma_f32_32x32x16_bf16 v[128:143], v[36:39], v[220:223], v[128:143]
    v_exp_f32 v118, v118
    v_exp_f32 v119, v119
    v_cvt_pk_bf16_f32 v146, v116, v117
    v_cvt_pk_bf16_f32 v147, v118, v119
    v_exp_f32 v120, v120
    v_exp_f32 v121, v121
    v_mfma_f32_32x32x16_bf16 v[64:79], v[44:47], v[148:151], v[64:79]
    v_exp_f32 v122, v122
    v_exp_f32 v123, v123
    v_cvt_pk_bf16_f32 v148, v120, v121
    v_cvt_pk_bf16_f32 v149, v122, v123
    v_exp_f32 v124, v124
    v_exp_f32 v125, v125
    v_mfma_f32_32x32x16_bf16 v[80:95], v[40:43], v[144:147], v[80:95]
    s_waitcnt lgkmcnt(0)
    v_exp_f32 v126, v126
    v_exp_f32 v127, v127
    v_cvt_pk_bf16_f32 v150, v124, v125
    v_cvt_pk_bf16_f32 v151, v126, v127
    v_exp_f32 v128, v128
    v_exp_f32 v129, v129
    v_mfma_f32_32x32x16_bf16 v[112:127], v[16:19], v[192:195], 0
    v_exp_f32 v130, v130
    v_exp_f32 v131, v131
    v_cvt_pk_bf16_f32 v144, v128, v129
    v_cvt_pk_bf16_f32 v145, v130, v131
    v_exp_f32 v132, v132
    v_exp_f32 v133, v133
    v_mfma_f32_32x32x16_bf16 v[112:127], v[20:23], v[196:199], v[112:127]
    v_exp_f32 v134, v134
    v_exp_f32 v135, v135
    v_cvt_pk_bf16_f32 v146, v132, v133
    v_cvt_pk_bf16_f32 v147, v134, v135
    v_exp_f32 v136, v136
    v_exp_f32 v137, v137
    v_mfma_f32_32x32x16_bf16 v[80:95], v[44:47], v[148:151], v[80:95]
    v_exp_f32 v138, v138
    v_exp_f32 v139, v139
    v_cvt_pk_bf16_f32 v148, v136, v137
    v_cvt_pk_bf16_f32 v149, v138, v139
    v_exp_f32 v140, v140
    v_exp_f32 v141, v141
    v_mfma_f32_32x32x16_bf16 v[96:111], v[40:43], v[144:147], v[96:111]
    v_exp_f32 v142, v142
    v_exp_f32 v143, v143
    v_cvt_pk_bf16_f32 v150, v140, v141
    v_cvt_pk_bf16_f32 v151, v142, v143
    v_exp_f32 v112, v112
    v_exp_f32 v113, v113
    v_mfma_f32_32x32x16_bf16 v[128:143], v[16:19], v[200:203], 0
    v_exp_f32 v114, v114
    v_exp_f32 v115, v115
    v_cvt_pk_bf16_f32 v144, v112, v113
    v_cvt_pk_bf16_f32 v145, v114, v115
    v_exp_f32 v116, v116
    v_exp_f32 v117, v117
    v_mfma_f32_32x32x16_bf16 v[128:143], v[20:23], v[204:207], v[128:143]
    v_exp_f32 v118, v118
    v_exp_f32 v119, v119
    v_cvt_pk_bf16_f32 v146, v116, v117
    v_cvt_pk_bf16_f32 v147, v118, v119
    v_exp_f32 v120, v120
    v_exp_f32 v121, v121
    v_mfma_f32_32x32x16_bf16 v[96:111], v[44:47], v[148:151], v[96:111]
    v_exp_f32 v122, v122
    v_exp_f32 v123, v123
    v_cvt_pk_bf16_f32 v148, v120, v121
    v_cvt_pk_bf16_f32 v149, v122, v123
    v_exp_f32 v124, v124
    v_exp_f32 v125, v125
    v_mfma_f32_32x32x16_bf16 v[48:63], v[24:27], v[144:147], v[48:63]
    ds_read2_b64 v[32:35], v231 offset0:0 offset1:64
    v_exp_f32 v126, v126
    v_exp_f32 v127, v127
    v_cvt_pk_bf16_f32 v150, v124, v125
    v_cvt_pk_bf16_f32 v151, v126, v127
    v_exp_f32 v128, v128
    v_exp_f32 v129, v129
    v_mfma_f32_32x32x16_bf16 v[112:127], v[16:19], v[208:211], 0
    ds_read2_b64 v[36:39], v231 offset0:128 offset1:192
    v_exp_f32 v130, v130
    v_exp_f32 v131, v131
    v_cvt_pk_bf16_f32 v144, v128, v129
    v_cvt_pk_bf16_f32 v145, v130, v131
    v_exp_f32 v132, v132
    v_exp_f32 v133, v133
    v_mfma_f32_32x32x16_bf16 v[112:127], v[20:23], v[212:215], v[112:127]
    ds_read_b128 v[40:43], v233 offset:4096
    v_exp_f32 v134, v134
    v_exp_f32 v135, v135
    v_cvt_pk_bf16_f32 v146, v132, v133
    v_cvt_pk_bf16_f32 v147, v134, v135
    v_exp_f32 v136, v136
    v_exp_f32 v137, v137
    v_mfma_f32_32x32x16_bf16 v[48:63], v[28:31], v[148:151], v[48:63]
    ds_read_b128 v[44:47], v233 offset:5120
    v_exp_f32 v138, v138
    v_exp_f32 v139, v139
    v_cvt_pk_bf16_f32 v148, v136, v137
    v_cvt_pk_bf16_f32 v149, v138, v139
    v_exp_f32 v140, v140
    v_exp_f32 v141, v141
    v_mfma_f32_32x32x16_bf16 v[64:79], v[24:27], v[144:147], v[64:79]
    v_exp_f32 v142, v142
    v_exp_f32 v143, v143
    v_cvt_pk_bf16_f32 v150, v140, v141
    v_cvt_pk_bf16_f32 v151, v142, v143
    v_exp_f32 v112, v112
    v_exp_f32 v113, v113
    v_mfma_f32_32x32x16_bf16 v[128:143], v[16:19], v[216:219], 0
    v_exp_f32 v114, v114
    v_exp_f32 v115, v115
    v_cvt_pk_bf16_f32 v144, v112, v113
    v_cvt_pk_bf16_f32 v145, v114, v115
    v_exp_f32 v116, v116
    v_exp_f32 v117, v117
    v_mfma_f32_32x32x16_bf16 v[128:143], v[20:23], v[220:223], v[128:143]
    v_exp_f32 v118, v118
    v_exp_f32 v119, v119
    v_cvt_pk_bf16_f32 v146, v116, v117
    v_cvt_pk_bf16_f32 v147, v118, v119
    v_exp_f32 v120, v120
    v_exp_f32 v121, v121
    v_mfma_f32_32x32x16_bf16 v[64:79], v[28:31], v[148:151], v[64:79]
    v_exp_f32 v122, v122
    v_exp_f32 v123, v123
    v_cvt_pk_bf16_f32 v148, v120, v121
    v_cvt_pk_bf16_f32 v149, v122, v123
    v_exp_f32 v124, v124
    v_exp_f32 v125, v125
    v_mfma_f32_32x32x16_bf16 v[80:95], v[24:27], v[144:147], v[80:95]
    s_waitcnt lgkmcnt(0)
    v_exp_f32 v126, v126
    v_exp_f32 v127, v127
    v_cvt_pk_bf16_f32 v150, v124, v125
    v_cvt_pk_bf16_f32 v151, v126, v127
    v_exp_f32 v128, v128
    v_exp_f32 v129, v129
    v_mfma_f32_32x32x16_bf16 v[112:127], v[32:35], v[192:195], 0
    v_exp_f32 v130, v130
    v_exp_f32 v131, v131
    v_cvt_pk_bf16_f32 v144, v128, v129
    v_cvt_pk_bf16_f32 v145, v130, v131
    v_exp_f32 v132, v132
    v_exp_f32 v133, v133
    v_mfma_f32_32x32x16_bf16 v[112:127], v[36:39], v[196:199], v[112:127]
    v_exp_f32 v134, v134
    v_exp_f32 v135, v135
    v_cvt_pk_bf16_f32 v146, v132, v133
    v_cvt_pk_bf16_f32 v147, v134, v135
    v_exp_f32 v136, v136
    v_exp_f32 v137, v137
    v_mfma_f32_32x32x16_bf16 v[80:95], v[28:31], v[148:151], v[80:95]
    v_exp_f32 v138, v138
    v_exp_f32 v139, v139
    v_cvt_pk_bf16_f32 v148, v136, v137
    v_cvt_pk_bf16_f32 v149, v138, v139
    v_exp_f32 v140, v140
    v_exp_f32 v141, v141
    v_mfma_f32_32x32x16_bf16 v[96:111], v[24:27], v[144:147], v[96:111]
    v_exp_f32 v142, v142
    v_exp_f32 v143, v143
    v_cvt_pk_bf16_f32 v150, v140, v141
    v_cvt_pk_bf16_f32 v151, v142, v143
    v_exp_f32 v112, v112
    v_exp_f32 v113, v113
    v_mfma_f32_32x32x16_bf16 v[128:143], v[32:35], v[200:203], 0
    v_exp_f32 v114, v114
    v_exp_f32 v115, v115
    v_cvt_pk_bf16_f32 v144, v112, v113
    v_cvt_pk_bf16_f32 v145, v114, v115
    v_exp_f32 v116, v116
    v_exp_f32 v117, v117
    v_mfma_f32_32x32x16_bf16 v[128:143], v[36:39], v[204:207], v[128:143]
    v_exp_f32 v118, v118
    v_exp_f32 v119, v119
    v_cvt_pk_bf16_f32 v146, v116, v117
    v_cvt_pk_bf16_f32 v147, v118, v119
    v_exp_f32 v120, v120
    v_exp_f32 v121, v121
    v_mfma_f32_32x32x16_bf16 v[96:111], v[28:31], v[148:151], v[96:111]
    s_barrier
    v_exp_f32 v122, v122
    v_exp_f32 v123, v123
    v_cvt_pk_bf16_f32 v148, v120, v121
    v_cvt_pk_bf16_f32 v149, v122, v123
    v_exp_f32 v124, v124
    v_exp_f32 v125, v125
    v_mfma_f32_32x32x16_bf16 v[48:63], v[40:43], v[144:147], v[48:63]
    ds_read2_b64 v[16:19], v226 offset0:0 offset1:64
    v_exp_f32 v126, v126
    v_exp_f32 v127, v127
    v_cvt_pk_bf16_f32 v150, v124, v125
    v_cvt_pk_bf16_f32 v151, v126, v127
    v_exp_f32 v128, v128
    v_exp_f32 v129, v129
    v_mfma_f32_32x32x16_bf16 v[112:127], v[32:35], v[208:211], 0
    ds_read2_b64 v[20:23], v226 offset0:128 offset1:192
    v_exp_f32 v130, v130
    v_exp_f32 v131, v131
    v_cvt_pk_bf16_f32 v144, v128, v129
    v_cvt_pk_bf16_f32 v145, v130, v131
    v_exp_f32 v132, v132
    v_exp_f32 v133, v133
    v_mfma_f32_32x32x16_bf16 v[112:127], v[36:39], v[212:215], v[112:127]
    ds_read_b128 v[24:27], v232 offset:32768
    v_exp_f32 v134, v134
    v_exp_f32 v135, v135
    v_cvt_pk_bf16_f32 v146, v132, v133
    v_cvt_pk_bf16_f32 v147, v134, v135
    v_exp_f32 v136, v136
    v_exp_f32 v137, v137
    v_mfma_f32_32x32x16_bf16 v[48:63], v[44:47], v[148:151], v[48:63]
    ds_read_b128 v[28:31], v232 offset:33792
    v_exp_f32 v138, v138
    v_exp_f32 v139, v139
    v_cvt_pk_bf16_f32 v148, v136, v137
    v_cvt_pk_bf16_f32 v149, v138, v139
    v_exp_f32 v140, v140
    v_exp_f32 v141, v141
    v_mfma_f32_32x32x16_bf16 v[64:79], v[40:43], v[144:147], v[64:79]
    v_exp_f32 v142, v142
    v_exp_f32 v143, v143
    v_cvt_pk_bf16_f32 v150, v140, v141
    v_cvt_pk_bf16_f32 v151, v142, v143
    v_exp_f32 v112, v112
    v_exp_f32 v113, v113
    v_mfma_f32_32x32x16_bf16 v[128:143], v[32:35], v[216:219], 0
    v_exp_f32 v114, v114
    v_exp_f32 v115, v115
    v_cvt_pk_bf16_f32 v144, v112, v113
    v_cvt_pk_bf16_f32 v145, v114, v115
    v_exp_f32 v116, v116
    v_exp_f32 v117, v117
    v_mfma_f32_32x32x16_bf16 v[128:143], v[36:39], v[220:223], v[128:143]
    v_exp_f32 v118, v118
    v_exp_f32 v119, v119
    v_cvt_pk_bf16_f32 v146, v116, v117
    v_cvt_pk_bf16_f32 v147, v118, v119
    v_exp_f32 v120, v120
    v_exp_f32 v121, v121
    v_mfma_f32_32x32x16_bf16 v[64:79], v[44:47], v[148:151], v[64:79]
    v_exp_f32 v122, v122
    v_exp_f32 v123, v123
    v_cvt_pk_bf16_f32 v148, v120, v121
    v_cvt_pk_bf16_f32 v149, v122, v123
    v_exp_f32 v124, v124
    v_exp_f32 v125, v125
    v_mfma_f32_32x32x16_bf16 v[80:95], v[40:43], v[144:147], v[80:95]
    s_waitcnt lgkmcnt(0)
    v_exp_f32 v126, v126
    v_exp_f32 v127, v127
    v_cvt_pk_bf16_f32 v150, v124, v125
    v_cvt_pk_bf16_f32 v151, v126, v127
    v_exp_f32 v128, v128
    v_exp_f32 v129, v129
    v_mfma_f32_32x32x16_bf16 v[112:127], v[16:19], v[192:195], 0
    v_exp_f32 v130, v130
    v_exp_f32 v131, v131
    v_cvt_pk_bf16_f32 v144, v128, v129
    v_cvt_pk_bf16_f32 v145, v130, v131
    v_exp_f32 v132, v132
    v_exp_f32 v133, v133
    v_mfma_f32_32x32x16_bf16 v[112:127], v[20:23], v[196:199], v[112:127]
    v_exp_f32 v134, v134
    v_exp_f32 v135, v135
    v_cvt_pk_bf16_f32 v146, v132, v133
    v_cvt_pk_bf16_f32 v147, v134, v135
    v_exp_f32 v136, v136
    v_exp_f32 v137, v137
    v_mfma_f32_32x32x16_bf16 v[80:95], v[44:47], v[148:151], v[80:95]
    v_exp_f32 v138, v138
    v_exp_f32 v139, v139
    v_cvt_pk_bf16_f32 v148, v136, v137
    v_cvt_pk_bf16_f32 v149, v138, v139
    v_exp_f32 v140, v140
    v_exp_f32 v141, v141
    v_mfma_f32_32x32x16_bf16 v[96:111], v[40:43], v[144:147], v[96:111]
    v_exp_f32 v142, v142
    v_exp_f32 v143, v143
    v_cvt_pk_bf16_f32 v150, v140, v141
    v_cvt_pk_bf16_f32 v151, v142, v143
    v_exp_f32 v112, v112
    v_exp_f32 v113, v113
    v_mfma_f32_32x32x16_bf16 v[128:143], v[16:19], v[200:203], 0
    v_exp_f32 v114, v114
    v_exp_f32 v115, v115
    v_cvt_pk_bf16_f32 v144, v112, v113
    v_cvt_pk_bf16_f32 v145, v114, v115
    v_exp_f32 v116, v116
    v_exp_f32 v117, v117
    v_mfma_f32_32x32x16_bf16 v[128:143], v[20:23], v[204:207], v[128:143]
    v_exp_f32 v118, v118
    v_exp_f32 v119, v119
    v_cvt_pk_bf16_f32 v146, v116, v117
    v_cvt_pk_bf16_f32 v147, v118, v119
    v_exp_f32 v120, v120
    v_exp_f32 v121, v121
    v_mfma_f32_32x32x16_bf16 v[96:111], v[44:47], v[148:151], v[96:111]
    v_exp_f32 v122, v122
    v_exp_f32 v123, v123
    v_cvt_pk_bf16_f32 v148, v120, v121
    v_cvt_pk_bf16_f32 v149, v122, v123
    v_exp_f32 v124, v124
    v_exp_f32 v125, v125
    v_mfma_f32_32x32x16_bf16 v[48:63], v[24:27], v[144:147], v[48:63]
    ds_read2_b64 v[32:35], v227 offset0:0 offset1:64
    v_exp_f32 v126, v126
    v_exp_f32 v127, v127
    v_cvt_pk_bf16_f32 v150, v124, v125
    v_cvt_pk_bf16_f32 v151, v126, v127
    v_exp_f32 v128, v128
    v_exp_f32 v129, v129
    v_mfma_f32_32x32x16_bf16 v[112:127], v[16:19], v[208:211], 0
    ds_read2_b64 v[36:39], v227 offset0:128 offset1:192
    v_exp_f32 v130, v130
    v_exp_f32 v131, v131
    v_cvt_pk_bf16_f32 v144, v128, v129
    v_cvt_pk_bf16_f32 v145, v130, v131
    v_exp_f32 v132, v132
    v_exp_f32 v133, v133
    v_mfma_f32_32x32x16_bf16 v[112:127], v[20:23], v[212:215], v[112:127]
    ds_read_b128 v[40:43], v232 offset:36864
    v_exp_f32 v134, v134
    v_exp_f32 v135, v135
    v_cvt_pk_bf16_f32 v146, v132, v133
    v_cvt_pk_bf16_f32 v147, v134, v135
    v_exp_f32 v136, v136
    v_exp_f32 v137, v137
    v_mfma_f32_32x32x16_bf16 v[48:63], v[28:31], v[148:151], v[48:63]
    ds_read_b128 v[44:47], v232 offset:37888
    v_exp_f32 v138, v138
    v_exp_f32 v139, v139
    v_cvt_pk_bf16_f32 v148, v136, v137
    v_cvt_pk_bf16_f32 v149, v138, v139
    v_exp_f32 v140, v140
    v_exp_f32 v141, v141
    v_mfma_f32_32x32x16_bf16 v[64:79], v[24:27], v[144:147], v[64:79]
    v_exp_f32 v142, v142
    v_exp_f32 v143, v143
    v_cvt_pk_bf16_f32 v150, v140, v141
    v_cvt_pk_bf16_f32 v151, v142, v143
    v_exp_f32 v112, v112
    v_exp_f32 v113, v113
    v_mfma_f32_32x32x16_bf16 v[128:143], v[16:19], v[216:219], 0
    v_exp_f32 v114, v114
    v_exp_f32 v115, v115
    v_cvt_pk_bf16_f32 v144, v112, v113
    v_cvt_pk_bf16_f32 v145, v114, v115
    v_exp_f32 v116, v116
    v_exp_f32 v117, v117
    v_mfma_f32_32x32x16_bf16 v[128:143], v[20:23], v[220:223], v[128:143]
    v_exp_f32 v118, v118
    v_exp_f32 v119, v119
    v_cvt_pk_bf16_f32 v146, v116, v117
    v_cvt_pk_bf16_f32 v147, v118, v119
    v_exp_f32 v120, v120
    v_exp_f32 v121, v121
    v_mfma_f32_32x32x16_bf16 v[64:79], v[28:31], v[148:151], v[64:79]
    v_exp_f32 v122, v122
    v_exp_f32 v123, v123
    v_cvt_pk_bf16_f32 v148, v120, v121
    v_cvt_pk_bf16_f32 v149, v122, v123
    v_exp_f32 v124, v124
    v_exp_f32 v125, v125
    v_mfma_f32_32x32x16_bf16 v[80:95], v[24:27], v[144:147], v[80:95]
    s_waitcnt lgkmcnt(0)
    v_exp_f32 v126, v126
    v_exp_f32 v127, v127
    v_cvt_pk_bf16_f32 v150, v124, v125
    v_cvt_pk_bf16_f32 v151, v126, v127
    v_exp_f32 v128, v128
    v_exp_f32 v129, v129
    v_mfma_f32_32x32x16_bf16 v[112:127], v[32:35], v[192:195], 0
    v_exp_f32 v130, v130
    v_exp_f32 v131, v131
    v_cvt_pk_bf16_f32 v144, v128, v129
    v_cvt_pk_bf16_f32 v145, v130, v131
    v_exp_f32 v132, v132
    v_exp_f32 v133, v133
    v_mfma_f32_32x32x16_bf16 v[112:127], v[36:39], v[196:199], v[112:127]
    v_exp_f32 v134, v134
    v_exp_f32 v135, v135
    v_cvt_pk_bf16_f32 v146, v132, v133
    v_cvt_pk_bf16_f32 v147, v134, v135
    v_exp_f32 v136, v136
    v_exp_f32 v137, v137
    v_mfma_f32_32x32x16_bf16 v[80:95], v[28:31], v[148:151], v[80:95]
    v_exp_f32 v138, v138
    v_exp_f32 v139, v139
    v_cvt_pk_bf16_f32 v148, v136, v137
    v_cvt_pk_bf16_f32 v149, v138, v139
    v_exp_f32 v140, v140
    v_exp_f32 v141, v141
    v_mfma_f32_32x32x16_bf16 v[96:111], v[24:27], v[144:147], v[96:111]
    v_exp_f32 v142, v142
    v_exp_f32 v143, v143
    v_cvt_pk_bf16_f32 v150, v140, v141
    v_cvt_pk_bf16_f32 v151, v142, v143
    v_exp_f32 v112, v112
    v_exp_f32 v113, v113
    v_mfma_f32_32x32x16_bf16 v[128:143], v[32:35], v[200:203], 0
    v_exp_f32 v114, v114
    v_exp_f32 v115, v115
    v_cvt_pk_bf16_f32 v144, v112, v113
    v_cvt_pk_bf16_f32 v145, v114, v115
    v_exp_f32 v116, v116
    v_exp_f32 v117, v117
    v_mfma_f32_32x32x16_bf16 v[128:143], v[36:39], v[204:207], v[128:143]
    v_exp_f32 v118, v118
    v_exp_f32 v119, v119
    v_cvt_pk_bf16_f32 v146, v116, v117
    v_cvt_pk_bf16_f32 v147, v118, v119
    v_exp_f32 v120, v120
    v_exp_f32 v121, v121
    v_mfma_f32_32x32x16_bf16 v[96:111], v[28:31], v[148:151], v[96:111]
    s_barrier
    v_exp_f32 v122, v122
    v_exp_f32 v123, v123
    v_cvt_pk_bf16_f32 v148, v120, v121
    v_cvt_pk_bf16_f32 v149, v122, v123
    v_exp_f32 v124, v124
    v_exp_f32 v125, v125
    v_mfma_f32_32x32x16_bf16 v[48:63], v[40:43], v[144:147], v[48:63]
    ds_read2_b64 v[16:19], v228 offset0:0 offset1:64
    v_exp_f32 v126, v126
    v_exp_f32 v127, v127
    v_cvt_pk_bf16_f32 v150, v124, v125
    v_cvt_pk_bf16_f32 v151, v126, v127
    v_exp_f32 v128, v128
    v_exp_f32 v129, v129
    v_mfma_f32_32x32x16_bf16 v[112:127], v[32:35], v[208:211], 0
    ds_read2_b64 v[20:23], v228 offset0:128 offset1:192
    v_exp_f32 v130, v130
    v_exp_f32 v131, v131
    v_cvt_pk_bf16_f32 v144, v128, v129
    v_cvt_pk_bf16_f32 v145, v130, v131
    v_exp_f32 v132, v132
    v_exp_f32 v133, v133
    v_mfma_f32_32x32x16_bf16 v[112:127], v[36:39], v[212:215], v[112:127]
    ds_read_b128 v[24:27], v232 offset:0
    v_exp_f32 v134, v134
    v_exp_f32 v135, v135
    v_cvt_pk_bf16_f32 v146, v132, v133
    v_cvt_pk_bf16_f32 v147, v134, v135
    v_exp_f32 v136, v136
    v_exp_f32 v137, v137
    v_mfma_f32_32x32x16_bf16 v[48:63], v[44:47], v[148:151], v[48:63]
    ds_read_b128 v[28:31], v232 offset:1024
    v_exp_f32 v138, v138
    v_exp_f32 v139, v139
    v_cvt_pk_bf16_f32 v148, v136, v137
    v_cvt_pk_bf16_f32 v149, v138, v139
    v_exp_f32 v140, v140
    v_exp_f32 v141, v141
    v_mfma_f32_32x32x16_bf16 v[64:79], v[40:43], v[144:147], v[64:79]
    v_exp_f32 v142, v142
    v_exp_f32 v143, v143
    v_cvt_pk_bf16_f32 v150, v140, v141
    v_cvt_pk_bf16_f32 v151, v142, v143
    v_exp_f32 v112, v112
    v_exp_f32 v113, v113
    v_mfma_f32_32x32x16_bf16 v[128:143], v[32:35], v[216:219], 0
    v_exp_f32 v114, v114
    v_exp_f32 v115, v115
    v_cvt_pk_bf16_f32 v144, v112, v113
    v_cvt_pk_bf16_f32 v145, v114, v115
    v_exp_f32 v116, v116
    v_exp_f32 v117, v117
    v_mfma_f32_32x32x16_bf16 v[128:143], v[36:39], v[220:223], v[128:143]
    v_exp_f32 v118, v118
    v_exp_f32 v119, v119
    v_cvt_pk_bf16_f32 v146, v116, v117
    v_cvt_pk_bf16_f32 v147, v118, v119
    v_exp_f32 v120, v120
    v_exp_f32 v121, v121
    v_mfma_f32_32x32x16_bf16 v[64:79], v[44:47], v[148:151], v[64:79]
    v_exp_f32 v122, v122
    v_exp_f32 v123, v123
    v_cvt_pk_bf16_f32 v148, v120, v121
    v_cvt_pk_bf16_f32 v149, v122, v123
    v_exp_f32 v124, v124
    v_exp_f32 v125, v125
    v_mfma_f32_32x32x16_bf16 v[80:95], v[40:43], v[144:147], v[80:95]
    s_waitcnt lgkmcnt(0)
    v_exp_f32 v126, v126
    v_exp_f32 v127, v127
    v_cvt_pk_bf16_f32 v150, v124, v125
    v_cvt_pk_bf16_f32 v151, v126, v127
    v_exp_f32 v128, v128
    v_exp_f32 v129, v129
    v_mfma_f32_32x32x16_bf16 v[112:127], v[16:19], v[192:195], 0
    v_exp_f32 v130, v130
    v_exp_f32 v131, v131
    v_cvt_pk_bf16_f32 v144, v128, v129
    v_cvt_pk_bf16_f32 v145, v130, v131
    v_exp_f32 v132, v132
    v_exp_f32 v133, v133
    v_mfma_f32_32x32x16_bf16 v[112:127], v[20:23], v[196:199], v[112:127]
    v_exp_f32 v134, v134
    v_exp_f32 v135, v135
    v_cvt_pk_bf16_f32 v146, v132, v133
    v_cvt_pk_bf16_f32 v147, v134, v135
    v_exp_f32 v136, v136
    v_exp_f32 v137, v137
    v_mfma_f32_32x32x16_bf16 v[80:95], v[44:47], v[148:151], v[80:95]
    v_exp_f32 v138, v138
    v_exp_f32 v139, v139
    v_cvt_pk_bf16_f32 v148, v136, v137
    v_cvt_pk_bf16_f32 v149, v138, v139
    v_exp_f32 v140, v140
    v_exp_f32 v141, v141
    v_mfma_f32_32x32x16_bf16 v[96:111], v[40:43], v[144:147], v[96:111]
    v_exp_f32 v142, v142
    v_exp_f32 v143, v143
    v_cvt_pk_bf16_f32 v150, v140, v141
    v_cvt_pk_bf16_f32 v151, v142, v143
    v_exp_f32 v112, v112
    v_exp_f32 v113, v113
    v_mfma_f32_32x32x16_bf16 v[128:143], v[16:19], v[200:203], 0
    v_exp_f32 v114, v114
    v_exp_f32 v115, v115
    v_cvt_pk_bf16_f32 v144, v112, v113
    v_cvt_pk_bf16_f32 v145, v114, v115
    v_exp_f32 v116, v116
    v_exp_f32 v117, v117
    v_mfma_f32_32x32x16_bf16 v[128:143], v[20:23], v[204:207], v[128:143]
    v_exp_f32 v118, v118
    v_exp_f32 v119, v119
    v_cvt_pk_bf16_f32 v146, v116, v117
    v_cvt_pk_bf16_f32 v147, v118, v119
    v_exp_f32 v120, v120
    v_exp_f32 v121, v121
    v_mfma_f32_32x32x16_bf16 v[96:111], v[44:47], v[148:151], v[96:111]
    v_exp_f32 v122, v122
    v_exp_f32 v123, v123
    v_cvt_pk_bf16_f32 v148, v120, v121
    v_cvt_pk_bf16_f32 v149, v122, v123
    v_exp_f32 v124, v124
    v_exp_f32 v125, v125
    v_mfma_f32_32x32x16_bf16 v[48:63], v[24:27], v[144:147], v[48:63]
    ds_read2_b64 v[32:35], v229 offset0:0 offset1:64
    v_exp_f32 v126, v126
    v_exp_f32 v127, v127
    v_cvt_pk_bf16_f32 v150, v124, v125
    v_cvt_pk_bf16_f32 v151, v126, v127
    v_exp_f32 v128, v128
    v_exp_f32 v129, v129
    v_mfma_f32_32x32x16_bf16 v[112:127], v[16:19], v[208:211], 0
    ds_read2_b64 v[36:39], v229 offset0:128 offset1:192
    v_exp_f32 v130, v130
    v_exp_f32 v131, v131
    v_cvt_pk_bf16_f32 v144, v128, v129
    v_cvt_pk_bf16_f32 v145, v130, v131
    v_exp_f32 v132, v132
    v_exp_f32 v133, v133
    v_mfma_f32_32x32x16_bf16 v[112:127], v[20:23], v[212:215], v[112:127]
    ds_read_b128 v[40:43], v232 offset:4096
    v_exp_f32 v134, v134
    v_exp_f32 v135, v135
    v_cvt_pk_bf16_f32 v146, v132, v133
    v_cvt_pk_bf16_f32 v147, v134, v135
    v_exp_f32 v136, v136
    v_exp_f32 v137, v137
    v_mfma_f32_32x32x16_bf16 v[48:63], v[28:31], v[148:151], v[48:63]
    ds_read_b128 v[44:47], v232 offset:5120
    v_exp_f32 v138, v138
    v_exp_f32 v139, v139
    v_cvt_pk_bf16_f32 v148, v136, v137
    v_cvt_pk_bf16_f32 v149, v138, v139
    v_exp_f32 v140, v140
    v_exp_f32 v141, v141
    v_mfma_f32_32x32x16_bf16 v[64:79], v[24:27], v[144:147], v[64:79]
    v_exp_f32 v142, v142
    v_exp_f32 v143, v143
    v_cvt_pk_bf16_f32 v150, v140, v141
    v_cvt_pk_bf16_f32 v151, v142, v143
    v_exp_f32 v112, v112
    v_exp_f32 v113, v113
    v_mfma_f32_32x32x16_bf16 v[128:143], v[16:19], v[216:219], 0
    v_exp_f32 v114, v114
    v_exp_f32 v115, v115
    v_cvt_pk_bf16_f32 v144, v112, v113
    v_cvt_pk_bf16_f32 v145, v114, v115
    v_exp_f32 v116, v116
    v_exp_f32 v117, v117
    v_mfma_f32_32x32x16_bf16 v[128:143], v[20:23], v[220:223], v[128:143]
    v_exp_f32 v118, v118
    v_exp_f32 v119, v119
    v_cvt_pk_bf16_f32 v146, v116, v117
    v_cvt_pk_bf16_f32 v147, v118, v119
    v_exp_f32 v120, v120
    v_exp_f32 v121, v121
    v_mfma_f32_32x32x16_bf16 v[64:79], v[28:31], v[148:151], v[64:79]
    v_exp_f32 v122, v122
    v_exp_f32 v123, v123
    v_cvt_pk_bf16_f32 v148, v120, v121
    v_cvt_pk_bf16_f32 v149, v122, v123
    v_exp_f32 v124, v124
    v_exp_f32 v125, v125
    v_mfma_f32_32x32x16_bf16 v[80:95], v[24:27], v[144:147], v[80:95]
    s_waitcnt lgkmcnt(0)
    v_exp_f32 v126, v126
    v_exp_f32 v127, v127
    v_cvt_pk_bf16_f32 v150, v124, v125
    v_cvt_pk_bf16_f32 v151, v126, v127
    v_exp_f32 v128, v128
    v_exp_f32 v129, v129
    v_mfma_f32_32x32x16_bf16 v[112:127], v[32:35], v[192:195], 0
    v_exp_f32 v130, v130
    v_exp_f32 v131, v131
    v_cvt_pk_bf16_f32 v144, v128, v129
    v_cvt_pk_bf16_f32 v145, v130, v131
    v_exp_f32 v132, v132
    v_exp_f32 v133, v133
    v_mfma_f32_32x32x16_bf16 v[112:127], v[36:39], v[196:199], v[112:127]
    v_exp_f32 v134, v134
    v_exp_f32 v135, v135
    v_cvt_pk_bf16_f32 v146, v132, v133
    v_cvt_pk_bf16_f32 v147, v134, v135
    v_exp_f32 v136, v136
    v_exp_f32 v137, v137
    v_mfma_f32_32x32x16_bf16 v[80:95], v[28:31], v[148:151], v[80:95]
    v_exp_f32 v138, v138
    v_exp_f32 v139, v139
    v_cvt_pk_bf16_f32 v148, v136, v137
    v_cvt_pk_bf16_f32 v149, v138, v139
    v_exp_f32 v140, v140
    v_exp_f32 v141, v141
    v_mfma_f32_32x32x16_bf16 v[96:111], v[24:27], v[144:147], v[96:111]
    v_exp_f32 v142, v142
    v_exp_f32 v143, v143
    v_cvt_pk_bf16_f32 v150, v140, v141
    v_cvt_pk_bf16_f32 v151, v142, v143
    v_exp_f32 v112, v112
    v_exp_f32 v113, v113
    v_mfma_f32_32x32x16_bf16 v[128:143], v[32:35], v[200:203], 0
    v_exp_f32 v114, v114
    v_exp_f32 v115, v115
    v_cvt_pk_bf16_f32 v144, v112, v113
    v_cvt_pk_bf16_f32 v145, v114, v115
    v_exp_f32 v116, v116
    v_exp_f32 v117, v117
    v_mfma_f32_32x32x16_bf16 v[128:143], v[36:39], v[204:207], v[128:143]
    v_exp_f32 v118, v118
    v_exp_f32 v119, v119
    v_cvt_pk_bf16_f32 v146, v116, v117
    v_cvt_pk_bf16_f32 v147, v118, v119
    v_exp_f32 v120, v120
    v_exp_f32 v121, v121
    v_mfma_f32_32x32x16_bf16 v[96:111], v[28:31], v[148:151], v[96:111]
    s_barrier
    v_exp_f32 v122, v122
    v_exp_f32 v123, v123
    v_cvt_pk_bf16_f32 v148, v120, v121
    v_cvt_pk_bf16_f32 v149, v122, v123
    v_exp_f32 v124, v124
    v_exp_f32 v125, v125
    v_mfma_f32_32x32x16_bf16 v[48:63], v[40:43], v[144:147], v[48:63]
    ds_read2_b64 v[16:19], v230 offset0:0 offset1:64
    v_exp_f32 v126, v126
    v_exp_f32 v127, v127
    v_cvt_pk_bf16_f32 v150, v124, v125
    v_cvt_pk_bf16_f32 v151, v126, v127
    v_exp_f32 v128, v128
    v_exp_f32 v129, v129
    v_mfma_f32_32x32x16_bf16 v[112:127], v[32:35], v[208:211], 0
    ds_read2_b64 v[20:23], v230 offset0:128 offset1:192
    v_exp_f32 v130, v130
    v_exp_f32 v131, v131
    v_cvt_pk_bf16_f32 v144, v128, v129
    v_cvt_pk_bf16_f32 v145, v130, v131
    v_exp_f32 v132, v132
    v_exp_f32 v133, v133
    v_mfma_f32_32x32x16_bf16 v[112:127], v[36:39], v[212:215], v[112:127]
    ds_read_b128 v[24:27], v233 offset:0
    v_exp_f32 v134, v134
    v_exp_f32 v135, v135
    v_cvt_pk_bf16_f32 v146, v132, v133
    v_cvt_pk_bf16_f32 v147, v134, v135
    v_exp_f32 v136, v136
    v_exp_f32 v137, v137
    v_mfma_f32_32x32x16_bf16 v[48:63], v[44:47], v[148:151], v[48:63]
    ds_read_b128 v[28:31], v233 offset:1024
    v_exp_f32 v138, v138
    v_exp_f32 v139, v139
    v_cvt_pk_bf16_f32 v148, v136, v137
    v_cvt_pk_bf16_f32 v149, v138, v139
    v_exp_f32 v140, v140
    v_exp_f32 v141, v141
    v_mfma_f32_32x32x16_bf16 v[64:79], v[40:43], v[144:147], v[64:79]
    v_exp_f32 v142, v142
    v_exp_f32 v143, v143
    v_cvt_pk_bf16_f32 v150, v140, v141
    v_cvt_pk_bf16_f32 v151, v142, v143
    v_exp_f32 v112, v112
    v_exp_f32 v113, v113
    v_mfma_f32_32x32x16_bf16 v[128:143], v[32:35], v[216:219], 0
    v_exp_f32 v114, v114
    v_exp_f32 v115, v115
    v_cvt_pk_bf16_f32 v144, v112, v113
    v_cvt_pk_bf16_f32 v145, v114, v115
    v_exp_f32 v116, v116
    v_exp_f32 v117, v117
    v_mfma_f32_32x32x16_bf16 v[128:143], v[36:39], v[220:223], v[128:143]
    v_exp_f32 v118, v118
    v_exp_f32 v119, v119
    v_cvt_pk_bf16_f32 v146, v116, v117
    v_cvt_pk_bf16_f32 v147, v118, v119
    v_exp_f32 v120, v120
    v_exp_f32 v121, v121
    v_mfma_f32_32x32x16_bf16 v[64:79], v[44:47], v[148:151], v[64:79]
    v_exp_f32 v122, v122
    v_exp_f32 v123, v123
    v_cvt_pk_bf16_f32 v148, v120, v121
    v_cvt_pk_bf16_f32 v149, v122, v123
    v_exp_f32 v124, v124
    v_exp_f32 v125, v125
    v_mfma_f32_32x32x16_bf16 v[80:95], v[40:43], v[144:147], v[80:95]
    s_waitcnt lgkmcnt(0)
    v_exp_f32 v126, v126
    v_exp_f32 v127, v127
    v_cvt_pk_bf16_f32 v150, v124, v125
    v_cvt_pk_bf16_f32 v151, v126, v127
    v_exp_f32 v128, v128
    v_exp_f32 v129, v129
    v_mfma_f32_32x32x16_bf16 v[112:127], v[16:19], v[192:195], 0
    v_exp_f32 v130, v130
    v_exp_f32 v131, v131
    v_cvt_pk_bf16_f32 v144, v128, v129
    v_cvt_pk_bf16_f32 v145, v130, v131
    v_exp_f32 v132, v132
    v_exp_f32 v133, v133
    v_mfma_f32_32x32x16_bf16 v[112:127], v[20:23], v[196:199], v[112:127]
    v_exp_f32 v134, v134
    v_exp_f32 v135, v135
    v_cvt_pk_bf16_f32 v146, v132, v133
    v_cvt_pk_bf16_f32 v147, v134, v135
    v_exp_f32 v136, v136
    v_exp_f32 v137, v137
    v_mfma_f32_32x32x16_bf16 v[80:95], v[44:47], v[148:151], v[80:95]
    v_exp_f32 v138, v138
    v_exp_f32 v139, v139
    v_cvt_pk_bf16_f32 v148, v136, v137
    v_cvt_pk_bf16_f32 v149, v138, v139
    v_exp_f32 v140, v140
    v_exp_f32 v141, v141
    v_mfma_f32_32x32x16_bf16 v[96:111], v[40:43], v[144:147], v[96:111]
    v_exp_f32 v142, v142
    v_exp_f32 v143, v143
    v_cvt_pk_bf16_f32 v150, v140, v141
    v_cvt_pk_bf16_f32 v151, v142, v143
    v_exp_f32 v112, v112
    v_exp_f32 v113, v113
    v_mfma_f32_32x32x16_bf16 v[128:143], v[16:19], v[200:203], 0
    v_exp_f32 v114, v114
    v_exp_f32 v115, v115
    v_cvt_pk_bf16_f32 v144, v112, v113
    v_cvt_pk_bf16_f32 v145, v114, v115
    v_exp_f32 v116, v116
    v_exp_f32 v117, v117
    v_mfma_f32_32x32x16_bf16 v[128:143], v[20:23], v[204:207], v[128:143]
    v_exp_f32 v118, v118
    v_exp_f32 v119, v119
    v_cvt_pk_bf16_f32 v146, v116, v117
    v_cvt_pk_bf16_f32 v147, v118, v119
    v_exp_f32 v120, v120
    v_exp_f32 v121, v121
    v_mfma_f32_32x32x16_bf16 v[96:111], v[44:47], v[148:151], v[96:111]
    v_exp_f32 v122, v122
    v_exp_f32 v123, v123
    v_cvt_pk_bf16_f32 v148, v120, v121
    v_cvt_pk_bf16_f32 v149, v122, v123
    v_exp_f32 v124, v124
    v_exp_f32 v125, v125
    v_mfma_f32_32x32x16_bf16 v[48:63], v[24:27], v[144:147], v[48:63]
    ds_read2_b64 v[32:35], v231 offset0:0 offset1:64
    v_exp_f32 v126, v126
    v_exp_f32 v127, v127
    v_cvt_pk_bf16_f32 v150, v124, v125
    v_cvt_pk_bf16_f32 v151, v126, v127
    v_exp_f32 v128, v128
    v_exp_f32 v129, v129
    v_mfma_f32_32x32x16_bf16 v[112:127], v[16:19], v[208:211], 0
    ds_read2_b64 v[36:39], v231 offset0:128 offset1:192
    v_exp_f32 v130, v130
    v_exp_f32 v131, v131
    v_cvt_pk_bf16_f32 v144, v128, v129
    v_cvt_pk_bf16_f32 v145, v130, v131
    v_exp_f32 v132, v132
    v_exp_f32 v133, v133
    v_mfma_f32_32x32x16_bf16 v[112:127], v[20:23], v[212:215], v[112:127]
    ds_read_b128 v[40:43], v233 offset:4096
    v_exp_f32 v134, v134
    v_exp_f32 v135, v135
    v_cvt_pk_bf16_f32 v146, v132, v133
    v_cvt_pk_bf16_f32 v147, v134, v135
    v_exp_f32 v136, v136
    v_exp_f32 v137, v137
    v_mfma_f32_32x32x16_bf16 v[48:63], v[28:31], v[148:151], v[48:63]
    ds_read_b128 v[44:47], v233 offset:5120
    v_exp_f32 v138, v138
    v_exp_f32 v139, v139
    v_cvt_pk_bf16_f32 v148, v136, v137
    v_cvt_pk_bf16_f32 v149, v138, v139
    v_exp_f32 v140, v140
    v_exp_f32 v141, v141
    v_mfma_f32_32x32x16_bf16 v[64:79], v[24:27], v[144:147], v[64:79]
    v_exp_f32 v142, v142
    v_exp_f32 v143, v143
    v_cvt_pk_bf16_f32 v150, v140, v141
    v_cvt_pk_bf16_f32 v151, v142, v143
    v_exp_f32 v112, v112
    v_exp_f32 v113, v113
    v_mfma_f32_32x32x16_bf16 v[128:143], v[16:19], v[216:219], 0
    v_exp_f32 v114, v114
    v_exp_f32 v115, v115
    v_cvt_pk_bf16_f32 v144, v112, v113
    v_cvt_pk_bf16_f32 v145, v114, v115
    v_exp_f32 v116, v116
    v_exp_f32 v117, v117
    v_mfma_f32_32x32x16_bf16 v[128:143], v[20:23], v[220:223], v[128:143]
    v_exp_f32 v118, v118
    v_exp_f32 v119, v119
    v_cvt_pk_bf16_f32 v146, v116, v117
    v_cvt_pk_bf16_f32 v147, v118, v119
    v_exp_f32 v120, v120
    v_exp_f32 v121, v121
    v_mfma_f32_32x32x16_bf16 v[64:79], v[28:31], v[148:151], v[64:79]
    v_exp_f32 v122, v122
    v_exp_f32 v123, v123
    v_cvt_pk_bf16_f32 v148, v120, v121
    v_cvt_pk_bf16_f32 v149, v122, v123
    v_exp_f32 v124, v124
    v_exp_f32 v125, v125
    v_mfma_f32_32x32x16_bf16 v[80:95], v[24:27], v[144:147], v[80:95]
    s_waitcnt lgkmcnt(0)
    v_exp_f32 v126, v126
    v_exp_f32 v127, v127
    v_cvt_pk_bf16_f32 v150, v124, v125
    v_cvt_pk_bf16_f32 v151, v126, v127
    v_exp_f32 v128, v128
    v_exp_f32 v129, v129
    v_mfma_f32_32x32x16_bf16 v[112:127], v[32:35], v[192:195], 0
    v_exp_f32 v130, v130
    v_exp_f32 v131, v131
    v_cvt_pk_bf16_f32 v144, v128, v129
    v_cvt_pk_bf16_f32 v145, v130, v131
    v_exp_f32 v132, v132
    v_exp_f32 v133, v133
    v_mfma_f32_32x32x16_bf16 v[112:127], v[36:39], v[196:199], v[112:127]
    v_exp_f32 v134, v134
    v_exp_f32 v135, v135
    v_cvt_pk_bf16_f32 v146, v132, v133
    v_cvt_pk_bf16_f32 v147, v134, v135
    v_exp_f32 v136, v136
    v_exp_f32 v137, v137
    v_mfma_f32_32x32x16_bf16 v[80:95], v[28:31], v[148:151], v[80:95]
    v_exp_f32 v138, v138
    v_exp_f32 v139, v139
    v_cvt_pk_bf16_f32 v148, v136, v137
    v_cvt_pk_bf16_f32 v149, v138, v139
    v_exp_f32 v140, v140
    v_exp_f32 v141, v141
    v_mfma_f32_32x32x16_bf16 v[96:111], v[24:27], v[144:147], v[96:111]
    v_exp_f32 v142, v142
    v_exp_f32 v143, v143
    v_cvt_pk_bf16_f32 v150, v140, v141
    v_cvt_pk_bf16_f32 v151, v142, v143
    v_exp_f32 v112, v112
    v_exp_f32 v113, v113
    v_mfma_f32_32x32x16_bf16 v[128:143], v[32:35], v[200:203], 0
    v_exp_f32 v114, v114
    v_exp_f32 v115, v115
    v_cvt_pk_bf16_f32 v144, v112, v113
    v_cvt_pk_bf16_f32 v145, v114, v115
    v_exp_f32 v116, v116
    v_exp_f32 v117, v117
    v_mfma_f32_32x32x16_bf16 v[128:143], v[36:39], v[204:207], v[128:143]
    v_exp_f32 v118, v118
    v_exp_f32 v119, v119
    v_cvt_pk_bf16_f32 v146, v116, v117
    v_cvt_pk_bf16_f32 v147, v118, v119
    v_exp_f32 v120, v120
    v_exp_f32 v121, v121
    v_mfma_f32_32x32x16_bf16 v[96:111], v[28:31], v[148:151], v[96:111]
    s_barrier
    v_exp_f32 v122, v122
    v_exp_f32 v123, v123
    v_cvt_pk_bf16_f32 v148, v120, v121
    v_cvt_pk_bf16_f32 v149, v122, v123
    v_exp_f32 v124, v124
    v_exp_f32 v125, v125
    v_mfma_f32_32x32x16_bf16 v[48:63], v[40:43], v[144:147], v[48:63]
    ds_read2_b64 v[16:19], v226 offset0:0 offset1:64
    v_exp_f32 v126, v126
    v_exp_f32 v127, v127
    v_cvt_pk_bf16_f32 v150, v124, v125
    v_cvt_pk_bf16_f32 v151, v126, v127
    v_exp_f32 v128, v128
    v_exp_f32 v129, v129
    v_mfma_f32_32x32x16_bf16 v[112:127], v[32:35], v[208:211], 0
    ds_read2_b64 v[20:23], v226 offset0:128 offset1:192
    v_exp_f32 v130, v130
    v_exp_f32 v131, v131
    v_cvt_pk_bf16_f32 v144, v128, v129
    v_cvt_pk_bf16_f32 v145, v130, v131
    v_exp_f32 v132, v132
    v_exp_f32 v133, v133
    v_mfma_f32_32x32x16_bf16 v[112:127], v[36:39], v[212:215], v[112:127]
    ds_read_b128 v[24:27], v232 offset:32768
    v_exp_f32 v134, v134
    v_exp_f32 v135, v135
    v_cvt_pk_bf16_f32 v146, v132, v133
    v_cvt_pk_bf16_f32 v147, v134, v135
    v_exp_f32 v136, v136
    v_exp_f32 v137, v137
    v_mfma_f32_32x32x16_bf16 v[48:63], v[44:47], v[148:151], v[48:63]
    ds_read_b128 v[28:31], v232 offset:33792
    v_exp_f32 v138, v138
    v_exp_f32 v139, v139
    v_cvt_pk_bf16_f32 v148, v136, v137
    v_cvt_pk_bf16_f32 v149, v138, v139
    v_exp_f32 v140, v140
    v_exp_f32 v141, v141
    v_mfma_f32_32x32x16_bf16 v[64:79], v[40:43], v[144:147], v[64:79]
    v_exp_f32 v142, v142
    v_exp_f32 v143, v143
    v_cvt_pk_bf16_f32 v150, v140, v141
    v_cvt_pk_bf16_f32 v151, v142, v143
    v_exp_f32 v112, v112
    v_exp_f32 v113, v113
    v_mfma_f32_32x32x16_bf16 v[128:143], v[32:35], v[216:219], 0
    v_exp_f32 v114, v114
    v_exp_f32 v115, v115
    v_cvt_pk_bf16_f32 v144, v112, v113
    v_cvt_pk_bf16_f32 v145, v114, v115
    v_exp_f32 v116, v116
    v_exp_f32 v117, v117
    v_mfma_f32_32x32x16_bf16 v[128:143], v[36:39], v[220:223], v[128:143]
    v_exp_f32 v118, v118
    v_exp_f32 v119, v119
    v_cvt_pk_bf16_f32 v146, v116, v117
    v_cvt_pk_bf16_f32 v147, v118, v119
    v_exp_f32 v120, v120
    v_exp_f32 v121, v121
    v_mfma_f32_32x32x16_bf16 v[64:79], v[44:47], v[148:151], v[64:79]
    v_exp_f32 v122, v122
    v_exp_f32 v123, v123
    v_cvt_pk_bf16_f32 v148, v120, v121
    v_cvt_pk_bf16_f32 v149, v122, v123
    v_exp_f32 v124, v124
    v_exp_f32 v125, v125
    v_mfma_f32_32x32x16_bf16 v[80:95], v[40:43], v[144:147], v[80:95]
    s_waitcnt lgkmcnt(0)
    v_exp_f32 v126, v126
    v_exp_f32 v127, v127
    v_cvt_pk_bf16_f32 v150, v124, v125
    v_cvt_pk_bf16_f32 v151, v126, v127
    v_exp_f32 v128, v128
    v_exp_f32 v129, v129
    v_mfma_f32_32x32x16_bf16 v[112:127], v[16:19], v[192:195], 0
    v_exp_f32 v130, v130
    v_exp_f32 v131, v131
    v_cvt_pk_bf16_f32 v144, v128, v129
    v_cvt_pk_bf16_f32 v145, v130, v131
    v_exp_f32 v132, v132
    v_exp_f32 v133, v133
    v_mfma_f32_32x32x16_bf16 v[112:127], v[20:23], v[196:199], v[112:127]
    v_exp_f32 v134, v134
    v_exp_f32 v135, v135
    v_cvt_pk_bf16_f32 v146, v132, v133
    v_cvt_pk_bf16_f32 v147, v134, v135
    v_exp_f32 v136, v136
    v_exp_f32 v137, v137
    v_mfma_f32_32x32x16_bf16 v[80:95], v[44:47], v[148:151], v[80:95]
    v_exp_f32 v138, v138
    v_exp_f32 v139, v139
    v_cvt_pk_bf16_f32 v148, v136, v137
    v_cvt_pk_bf16_f32 v149, v138, v139
    v_exp_f32 v140, v140
    v_exp_f32 v141, v141
    v_mfma_f32_32x32x16_bf16 v[96:111], v[40:43], v[144:147], v[96:111]
    v_exp_f32 v142, v142
    v_exp_f32 v143, v143
    v_cvt_pk_bf16_f32 v150, v140, v141
    v_cvt_pk_bf16_f32 v151, v142, v143
    v_exp_f32 v112, v112
    v_exp_f32 v113, v113
    v_mfma_f32_32x32x16_bf16 v[128:143], v[16:19], v[200:203], 0
    v_exp_f32 v114, v114
    v_exp_f32 v115, v115
    v_cvt_pk_bf16_f32 v144, v112, v113
    v_cvt_pk_bf16_f32 v145, v114, v115
    v_exp_f32 v116, v116
    v_exp_f32 v117, v117
    v_mfma_f32_32x32x16_bf16 v[128:143], v[20:23], v[204:207], v[128:143]
    v_exp_f32 v118, v118
    v_exp_f32 v119, v119
    v_cvt_pk_bf16_f32 v146, v116, v117
    v_cvt_pk_bf16_f32 v147, v118, v119
    v_exp_f32 v120, v120
    v_exp_f32 v121, v121
    v_mfma_f32_32x32x16_bf16 v[96:111], v[44:47], v[148:151], v[96:111]
    v_exp_f32 v122, v122
    v_exp_f32 v123, v123
    v_cvt_pk_bf16_f32 v148, v120, v121
    v_cvt_pk_bf16_f32 v149, v122, v123
    v_exp_f32 v124, v124
    v_exp_f32 v125, v125
    v_mfma_f32_32x32x16_bf16 v[48:63], v[24:27], v[144:147], v[48:63]
    ds_read2_b64 v[32:35], v227 offset0:0 offset1:64
    v_exp_f32 v126, v126
    v_exp_f32 v127, v127
    v_cvt_pk_bf16_f32 v150, v124, v125
    v_cvt_pk_bf16_f32 v151, v126, v127
    v_exp_f32 v128, v128
    v_exp_f32 v129, v129
    v_mfma_f32_32x32x16_bf16 v[112:127], v[16:19], v[208:211], 0
    ds_read2_b64 v[36:39], v227 offset0:128 offset1:192
    v_exp_f32 v130, v130
    v_exp_f32 v131, v131
    v_cvt_pk_bf16_f32 v144, v128, v129
    v_cvt_pk_bf16_f32 v145, v130, v131
    v_exp_f32 v132, v132
    v_exp_f32 v133, v133
    v_mfma_f32_32x32x16_bf16 v[112:127], v[20:23], v[212:215], v[112:127]
    ds_read_b128 v[40:43], v232 offset:36864
    v_exp_f32 v134, v134
    v_exp_f32 v135, v135
    v_cvt_pk_bf16_f32 v146, v132, v133
    v_cvt_pk_bf16_f32 v147, v134, v135
    v_exp_f32 v136, v136
    v_exp_f32 v137, v137
    v_mfma_f32_32x32x16_bf16 v[48:63], v[28:31], v[148:151], v[48:63]
    ds_read_b128 v[44:47], v232 offset:37888
    v_exp_f32 v138, v138
    v_exp_f32 v139, v139
    v_cvt_pk_bf16_f32 v148, v136, v137
    v_cvt_pk_bf16_f32 v149, v138, v139
    v_exp_f32 v140, v140
    v_exp_f32 v141, v141
    v_mfma_f32_32x32x16_bf16 v[64:79], v[24:27], v[144:147], v[64:79]
    v_exp_f32 v142, v142
    v_exp_f32 v143, v143
    v_cvt_pk_bf16_f32 v150, v140, v141
    v_cvt_pk_bf16_f32 v151, v142, v143
    v_exp_f32 v112, v112
    v_exp_f32 v113, v113
    v_mfma_f32_32x32x16_bf16 v[128:143], v[16:19], v[216:219], 0
    v_exp_f32 v114, v114
    v_exp_f32 v115, v115
    v_cvt_pk_bf16_f32 v144, v112, v113
    v_cvt_pk_bf16_f32 v145, v114, v115
    v_exp_f32 v116, v116
    v_exp_f32 v117, v117
    v_mfma_f32_32x32x16_bf16 v[128:143], v[20:23], v[220:223], v[128:143]
    v_exp_f32 v118, v118
    v_exp_f32 v119, v119
    v_cvt_pk_bf16_f32 v146, v116, v117
    v_cvt_pk_bf16_f32 v147, v118, v119
    v_exp_f32 v120, v120
    v_exp_f32 v121, v121
    v_mfma_f32_32x32x16_bf16 v[64:79], v[28:31], v[148:151], v[64:79]
    v_exp_f32 v122, v122
    v_exp_f32 v123, v123
    v_cvt_pk_bf16_f32 v148, v120, v121
    v_cvt_pk_bf16_f32 v149, v122, v123
    v_exp_f32 v124, v124
    v_exp_f32 v125, v125
    v_mfma_f32_32x32x16_bf16 v[80:95], v[24:27], v[144:147], v[80:95]
    s_waitcnt lgkmcnt(0)
    v_exp_f32 v126, v126
    v_exp_f32 v127, v127
    v_cvt_pk_bf16_f32 v150, v124, v125
    v_cvt_pk_bf16_f32 v151, v126, v127
    v_exp_f32 v128, v128
    v_exp_f32 v129, v129
    v_mfma_f32_32x32x16_bf16 v[112:127], v[32:35], v[192:195], 0
    v_exp_f32 v130, v130
    v_exp_f32 v131, v131
    v_cvt_pk_bf16_f32 v144, v128, v129
    v_cvt_pk_bf16_f32 v145, v130, v131
    v_exp_f32 v132, v132
    v_exp_f32 v133, v133
    v_mfma_f32_32x32x16_bf16 v[112:127], v[36:39], v[196:199], v[112:127]
    v_exp_f32 v134, v134
    v_exp_f32 v135, v135
    v_cvt_pk_bf16_f32 v146, v132, v133
    v_cvt_pk_bf16_f32 v147, v134, v135
    v_exp_f32 v136, v136
    v_exp_f32 v137, v137
    v_mfma_f32_32x32x16_bf16 v[80:95], v[28:31], v[148:151], v[80:95]
    v_exp_f32 v138, v138
    v_exp_f32 v139, v139
    v_cvt_pk_bf16_f32 v148, v136, v137
    v_cvt_pk_bf16_f32 v149, v138, v139
    v_exp_f32 v140, v140
    v_exp_f32 v141, v141
    v_mfma_f32_32x32x16_bf16 v[96:111], v[24:27], v[144:147], v[96:111]
    v_exp_f32 v142, v142
    v_exp_f32 v143, v143
    v_cvt_pk_bf16_f32 v150, v140, v141
    v_cvt_pk_bf16_f32 v151, v142, v143
    v_exp_f32 v112, v112
    v_exp_f32 v113, v113
    v_mfma_f32_32x32x16_bf16 v[128:143], v[32:35], v[200:203], 0
    v_exp_f32 v114, v114
    v_exp_f32 v115, v115
    v_cvt_pk_bf16_f32 v144, v112, v113
    v_cvt_pk_bf16_f32 v145, v114, v115
    v_exp_f32 v116, v116
    v_exp_f32 v117, v117
    v_mfma_f32_32x32x16_bf16 v[128:143], v[36:39], v[204:207], v[128:143]
    v_exp_f32 v118, v118
    v_exp_f32 v119, v119
    v_cvt_pk_bf16_f32 v146, v116, v117
    v_cvt_pk_bf16_f32 v147, v118, v119
    v_exp_f32 v120, v120
    v_exp_f32 v121, v121
    v_mfma_f32_32x32x16_bf16 v[96:111], v[28:31], v[148:151], v[96:111]
    s_barrier
    v_exp_f32 v122, v122
    v_exp_f32 v123, v123
    v_cvt_pk_bf16_f32 v148, v120, v121
    v_cvt_pk_bf16_f32 v149, v122, v123
    v_exp_f32 v124, v124
    v_exp_f32 v125, v125
    v_mfma_f32_32x32x16_bf16 v[48:63], v[40:43], v[144:147], v[48:63]
    ds_read2_b64 v[16:19], v228 offset0:0 offset1:64
    v_exp_f32 v126, v126
    v_exp_f32 v127, v127
    v_cvt_pk_bf16_f32 v150, v124, v125
    v_cvt_pk_bf16_f32 v151, v126, v127
    v_exp_f32 v128, v128
    v_exp_f32 v129, v129
    v_mfma_f32_32x32x16_bf16 v[112:127], v[32:35], v[208:211], 0
    ds_read2_b64 v[20:23], v228 offset0:128 offset1:192
    v_exp_f32 v130, v130
    v_exp_f32 v131, v131
    v_cvt_pk_bf16_f32 v144, v128, v129
    v_cvt_pk_bf16_f32 v145, v130, v131
    v_exp_f32 v132, v132
    v_exp_f32 v133, v133
    v_mfma_f32_32x32x16_bf16 v[112:127], v[36:39], v[212:215], v[112:127]
    ds_read_b128 v[24:27], v232 offset:0
    v_exp_f32 v134, v134
    v_exp_f32 v135, v135
    v_cvt_pk_bf16_f32 v146, v132, v133
    v_cvt_pk_bf16_f32 v147, v134, v135
    v_exp_f32 v136, v136
    v_exp_f32 v137, v137
    v_mfma_f32_32x32x16_bf16 v[48:63], v[44:47], v[148:151], v[48:63]
    ds_read_b128 v[28:31], v232 offset:1024
    v_exp_f32 v138, v138
    v_exp_f32 v139, v139
    v_cvt_pk_bf16_f32 v148, v136, v137
    v_cvt_pk_bf16_f32 v149, v138, v139
    v_exp_f32 v140, v140
    v_exp_f32 v141, v141
    v_mfma_f32_32x32x16_bf16 v[64:79], v[40:43], v[144:147], v[64:79]
    v_exp_f32 v142, v142
    v_exp_f32 v143, v143
    v_cvt_pk_bf16_f32 v150, v140, v141
    v_cvt_pk_bf16_f32 v151, v142, v143
    v_exp_f32 v112, v112
    v_exp_f32 v113, v113
    v_mfma_f32_32x32x16_bf16 v[128:143], v[32:35], v[216:219], 0
    v_exp_f32 v114, v114
    v_exp_f32 v115, v115
    v_cvt_pk_bf16_f32 v144, v112, v113
    v_cvt_pk_bf16_f32 v145, v114, v115
    v_exp_f32 v116, v116
    v_exp_f32 v117, v117
    v_mfma_f32_32x32x16_bf16 v[128:143], v[36:39], v[220:223], v[128:143]
    v_exp_f32 v118, v118
    v_exp_f32 v119, v119
    v_cvt_pk_bf16_f32 v146, v116, v117
    v_cvt_pk_bf16_f32 v147, v118, v119
    v_exp_f32 v120, v120
    v_exp_f32 v121, v121
    v_mfma_f32_32x32x16_bf16 v[64:79], v[44:47], v[148:151], v[64:79]
    v_exp_f32 v122, v122
    v_exp_f32 v123, v123
    v_cvt_pk_bf16_f32 v148, v120, v121
    v_cvt_pk_bf16_f32 v149, v122, v123
    v_exp_f32 v124, v124
    v_exp_f32 v125, v125
    v_mfma_f32_32x32x16_bf16 v[80:95], v[40:43], v[144:147], v[80:95]
    s_waitcnt lgkmcnt(0)
    v_exp_f32 v126, v126
    v_exp_f32 v127, v127
    v_cvt_pk_bf16_f32 v150, v124, v125
    v_cvt_pk_bf16_f32 v151, v126, v127
    v_exp_f32 v128, v128
    v_exp_f32 v129, v129
    v_mfma_f32_32x32x16_bf16 v[112:127], v[16:19], v[192:195], 0
    v_exp_f32 v130, v130
    v_exp_f32 v131, v131
    v_cvt_pk_bf16_f32 v144, v128, v129
    v_cvt_pk_bf16_f32 v145, v130, v131
    v_exp_f32 v132, v132
    v_exp_f32 v133, v133
    v_mfma_f32_32x32x16_bf16 v[112:127], v[20:23], v[196:199], v[112:127]
    v_exp_f32 v134, v134
    v_exp_f32 v135, v135
    v_cvt_pk_bf16_f32 v146, v132, v133
    v_cvt_pk_bf16_f32 v147, v134, v135
    v_exp_f32 v136, v136
    v_exp_f32 v137, v137
    v_mfma_f32_32x32x16_bf16 v[80:95], v[44:47], v[148:151], v[80:95]
    v_exp_f32 v138, v138
    v_exp_f32 v139, v139
    v_cvt_pk_bf16_f32 v148, v136, v137
    v_cvt_pk_bf16_f32 v149, v138, v139
    v_exp_f32 v140, v140
    v_exp_f32 v141, v141
    v_mfma_f32_32x32x16_bf16 v[96:111], v[40:43], v[144:147], v[96:111]
    v_exp_f32 v142, v142
    v_exp_f32 v143, v143
    v_cvt_pk_bf16_f32 v150, v140, v141
    v_cvt_pk_bf16_f32 v151, v142, v143
    v_exp_f32 v112, v112
    v_exp_f32 v113, v113
    v_mfma_f32_32x32x16_bf16 v[128:143], v[16:19], v[200:203], 0
    v_exp_f32 v114, v114
    v_exp_f32 v115, v115
    v_cvt_pk_bf16_f32 v144, v112, v113
    v_cvt_pk_bf16_f32 v145, v114, v115
    v_exp_f32 v116, v116
    v_exp_f32 v117, v117
    v_mfma_f32_32x32x16_bf16 v[128:143], v[20:23], v[204:207], v[128:143]
    v_exp_f32 v118, v118
    v_exp_f32 v119, v119
    v_cvt_pk_bf16_f32 v146, v116, v117
    v_cvt_pk_bf16_f32 v147, v118, v119
    v_exp_f32 v120, v120
    v_exp_f32 v121, v121
    v_mfma_f32_32x32x16_bf16 v[96:111], v[44:47], v[148:151], v[96:111]
    v_exp_f32 v122, v122
    v_exp_f32 v123, v123
    v_cvt_pk_bf16_f32 v148, v120, v121
    v_cvt_pk_bf16_f32 v149, v122, v123
    v_exp_f32 v124, v124
    v_exp_f32 v125, v125
    v_mfma_f32_32x32x16_bf16 v[48:63], v[24:27], v[144:147], v[48:63]
    ds_read2_b64 v[32:35], v229 offset0:0 offset1:64
    v_exp_f32 v126, v126
    v_exp_f32 v127, v127
    v_cvt_pk_bf16_f32 v150, v124, v125
    v_cvt_pk_bf16_f32 v151, v126, v127
    v_exp_f32 v128, v128
    v_exp_f32 v129, v129
    v_mfma_f32_32x32x16_bf16 v[112:127], v[16:19], v[208:211], 0
    ds_read2_b64 v[36:39], v229 offset0:128 offset1:192
    v_exp_f32 v130, v130
    v_exp_f32 v131, v131
    v_cvt_pk_bf16_f32 v144, v128, v129
    v_cvt_pk_bf16_f32 v145, v130, v131
    v_exp_f32 v132, v132
    v_exp_f32 v133, v133
    v_mfma_f32_32x32x16_bf16 v[112:127], v[20:23], v[212:215], v[112:127]
    ds_read_b128 v[40:43], v232 offset:4096
    v_exp_f32 v134, v134
    v_exp_f32 v135, v135
    v_cvt_pk_bf16_f32 v146, v132, v133
    v_cvt_pk_bf16_f32 v147, v134, v135
    v_exp_f32 v136, v136
    v_exp_f32 v137, v137
    v_mfma_f32_32x32x16_bf16 v[48:63], v[28:31], v[148:151], v[48:63]
    ds_read_b128 v[44:47], v232 offset:5120
    v_exp_f32 v138, v138
    v_exp_f32 v139, v139
    v_cvt_pk_bf16_f32 v148, v136, v137
    v_cvt_pk_bf16_f32 v149, v138, v139
    v_exp_f32 v140, v140
    v_exp_f32 v141, v141
    v_mfma_f32_32x32x16_bf16 v[64:79], v[24:27], v[144:147], v[64:79]
    v_exp_f32 v142, v142
    v_exp_f32 v143, v143
    v_cvt_pk_bf16_f32 v150, v140, v141
    v_cvt_pk_bf16_f32 v151, v142, v143
    v_exp_f32 v112, v112
    v_exp_f32 v113, v113
    v_mfma_f32_32x32x16_bf16 v[128:143], v[16:19], v[216:219], 0
    v_exp_f32 v114, v114
    v_exp_f32 v115, v115
    v_cvt_pk_bf16_f32 v144, v112, v113
    v_cvt_pk_bf16_f32 v145, v114, v115
    v_exp_f32 v116, v116
    v_exp_f32 v117, v117
    v_mfma_f32_32x32x16_bf16 v[128:143], v[20:23], v[220:223], v[128:143]
    v_exp_f32 v118, v118
    v_exp_f32 v119, v119
    v_cvt_pk_bf16_f32 v146, v116, v117
    v_cvt_pk_bf16_f32 v147, v118, v119
    v_exp_f32 v120, v120
    v_exp_f32 v121, v121
    v_mfma_f32_32x32x16_bf16 v[64:79], v[28:31], v[148:151], v[64:79]
    v_exp_f32 v122, v122
    v_exp_f32 v123, v123
    v_cvt_pk_bf16_f32 v148, v120, v121
    v_cvt_pk_bf16_f32 v149, v122, v123
    v_exp_f32 v124, v124
    v_exp_f32 v125, v125
    v_mfma_f32_32x32x16_bf16 v[80:95], v[24:27], v[144:147], v[80:95]
    s_waitcnt lgkmcnt(0)
    v_exp_f32 v126, v126
    v_exp_f32 v127, v127
    v_cvt_pk_bf16_f32 v150, v124, v125
    v_cvt_pk_bf16_f32 v151, v126, v127
    v_exp_f32 v128, v128
    v_exp_f32 v129, v129
    v_mfma_f32_32x32x16_bf16 v[112:127], v[32:35], v[192:195], 0
    v_exp_f32 v130, v130
    v_exp_f32 v131, v131
    v_cvt_pk_bf16_f32 v144, v128, v129
    v_cvt_pk_bf16_f32 v145, v130, v131
    v_exp_f32 v132, v132
    v_exp_f32 v133, v133
    v_mfma_f32_32x32x16_bf16 v[112:127], v[36:39], v[196:199], v[112:127]
    v_exp_f32 v134, v134
    v_exp_f32 v135, v135
    v_cvt_pk_bf16_f32 v146, v132, v133
    v_cvt_pk_bf16_f32 v147, v134, v135
    v_exp_f32 v136, v136
    v_exp_f32 v137, v137
    v_mfma_f32_32x32x16_bf16 v[80:95], v[28:31], v[148:151], v[80:95]
    v_exp_f32 v138, v138
    v_exp_f32 v139, v139
    v_cvt_pk_bf16_f32 v148, v136, v137
    v_cvt_pk_bf16_f32 v149, v138, v139
    v_exp_f32 v140, v140
    v_exp_f32 v141, v141
    v_mfma_f32_32x32x16_bf16 v[96:111], v[24:27], v[144:147], v[96:111]
    v_exp_f32 v142, v142
    v_exp_f32 v143, v143
    v_cvt_pk_bf16_f32 v150, v140, v141
    v_cvt_pk_bf16_f32 v151, v142, v143
    v_exp_f32 v112, v112
    v_exp_f32 v113, v113
    v_mfma_f32_32x32x16_bf16 v[128:143], v[32:35], v[200:203], 0
    v_exp_f32 v114, v114
    v_exp_f32 v115, v115
    v_cvt_pk_bf16_f32 v144, v112, v113
    v_cvt_pk_bf16_f32 v145, v114, v115
    v_exp_f32 v116, v116
    v_exp_f32 v117, v117
    v_mfma_f32_32x32x16_bf16 v[128:143], v[36:39], v[204:207], v[128:143]
    v_exp_f32 v118, v118
    v_exp_f32 v119, v119
    v_cvt_pk_bf16_f32 v146, v116, v117
    v_cvt_pk_bf16_f32 v147, v118, v119
    v_exp_f32 v120, v120
    v_exp_f32 v121, v121
    v_mfma_f32_32x32x16_bf16 v[96:111], v[28:31], v[148:151], v[96:111]
    v_exp_f32 v122, v122
    v_exp_f32 v123, v123
    v_cvt_pk_bf16_f32 v148, v120, v121
    v_cvt_pk_bf16_f32 v149, v122, v123
    v_exp_f32 v124, v124
    v_exp_f32 v125, v125
    v_mfma_f32_32x32x16_bf16 v[48:63], v[40:43], v[144:147], v[48:63]
    v_exp_f32 v126, v126
    v_exp_f32 v127, v127
    v_cvt_pk_bf16_f32 v150, v124, v125
    v_cvt_pk_bf16_f32 v151, v126, v127
    v_exp_f32 v128, v128
    v_exp_f32 v129, v129
    v_mfma_f32_32x32x16_bf16 v[112:127], v[32:35], v[208:211], 0
    v_exp_f32 v130, v130
    v_exp_f32 v131, v131
    v_cvt_pk_bf16_f32 v144, v128, v129
    v_cvt_pk_bf16_f32 v145, v130, v131
    v_exp_f32 v132, v132
    v_exp_f32 v133, v133
    v_mfma_f32_32x32x16_bf16 v[112:127], v[36:39], v[212:215], v[112:127]
    v_exp_f32 v134, v134
    v_exp_f32 v135, v135
    v_cvt_pk_bf16_f32 v146, v132, v133
    v_cvt_pk_bf16_f32 v147, v134, v135
    v_exp_f32 v136, v136
    v_exp_f32 v137, v137
    v_mfma_f32_32x32x16_bf16 v[48:63], v[44:47], v[148:151], v[48:63]
    v_exp_f32 v138, v138
    v_exp_f32 v139, v139
    v_cvt_pk_bf16_f32 v148, v136, v137
    v_cvt_pk_bf16_f32 v149, v138, v139
    v_exp_f32 v140, v140
    v_exp_f32 v141, v141
    v_mfma_f32_32x32x16_bf16 v[64:79], v[40:43], v[144:147], v[64:79]
    v_exp_f32 v142, v142
    v_exp_f32 v143, v143
    v_cvt_pk_bf16_f32 v150, v140, v141
    v_cvt_pk_bf16_f32 v151, v142, v143
    v_exp_f32 v112, v112
    v_exp_f32 v113, v113
    v_mfma_f32_32x32x16_bf16 v[128:143], v[32:35], v[216:219], 0
    s_mov_b32 exec_lo, 0
    v_mov_b32 v61, v152
    s_mov_b32 exec_lo, -1
    ds_write_b128 v234, v[48:51] offset:0
    v_exp_f32 v114, v114
    v_exp_f32 v115, v115
    v_cvt_pk_bf16_f32 v144, v112, v113
    v_cvt_pk_bf16_f32 v145, v114, v115
    v_exp_f32 v116, v116
    v_exp_f32 v117, v117
    v_mfma_f32_32x32x16_bf16 v[128:143], v[36:39], v[220:223], v[128:143]
    ds_write_b128 v234, v[52:55] offset:1024
    v_exp_f32 v118, v118
    v_exp_f32 v119, v119
    v_cvt_pk_bf16_f32 v146, v116, v117
    v_cvt_pk_bf16_f32 v147, v118, v119
    v_exp_f32 v120, v120
    v_exp_f32 v121, v121
    v_mfma_f32_32x32x16_bf16 v[64:79], v[44:47], v[148:151], v[64:79]
    ds_write_b128 v234, v[56:59] offset:2048
    v_exp_f32 v122, v122
    v_exp_f32 v123, v123
    v_cvt_pk_bf16_f32 v148, v120, v121
    v_cvt_pk_bf16_f32 v149, v122, v123
    v_exp_f32 v124, v124
    v_exp_f32 v125, v125
    v_mfma_f32_32x32x16_bf16 v[80:95], v[40:43], v[144:147], v[80:95]
    ds_write_b128 v234, v[60:63] offset:3072
    v_exp_f32 v126, v126
    v_exp_f32 v127, v127
    v_cvt_pk_bf16_f32 v150, v124, v125
    v_cvt_pk_bf16_f32 v151, v126, v127
    v_exp_f32 v128, v128
    v_exp_f32 v129, v129
    s_mov_b32 exec_lo, 0
    v_mov_b32 v77, v153
    s_mov_b32 exec_lo, -1
    ds_write_b128 v234, v[64:67] offset:4096
    v_exp_f32 v130, v130
    v_exp_f32 v131, v131
    v_cvt_pk_bf16_f32 v144, v128, v129
    v_cvt_pk_bf16_f32 v145, v130, v131
    v_exp_f32 v132, v132
    v_exp_f32 v133, v133
    ds_write_b128 v234, v[68:71] offset:5120
    v_exp_f32 v134, v134
    v_exp_f32 v135, v135
    v_cvt_pk_bf16_f32 v146, v132, v133
    v_cvt_pk_bf16_f32 v147, v134, v135
    v_exp_f32 v136, v136
    v_exp_f32 v137, v137
    v_mfma_f32_32x32x16_bf16 v[80:95], v[44:47], v[148:151], v[80:95]
    ds_write_b128 v234, v[72:75] offset:6144
    v_exp_f32 v138, v138
    v_exp_f32 v139, v139
    v_cvt_pk_bf16_f32 v148, v136, v137
    v_cvt_pk_bf16_f32 v149, v138, v139
    v_exp_f32 v140, v140
    v_exp_f32 v141, v141
    v_mfma_f32_32x32x16_bf16 v[96:111], v[40:43], v[144:147], v[96:111]
    ds_write_b128 v234, v[76:79] offset:7168
    v_exp_f32 v142, v142
    v_exp_f32 v143, v143
    v_cvt_pk_bf16_f32 v150, v140, v141
    v_cvt_pk_bf16_f32 v151, v142, v143
    s_nop 1
    v_mfma_f32_32x32x16_bf16 v[96:111], v[44:47], v[148:151], v[96:111]
    s_mov_b32 exec_lo, 0
    v_mov_b32 v93, v154
    s_mov_b32 exec_lo, -1
    ds_write_b128 v234, v[80:83] offset:8192
    ds_write_b128 v234, v[84:87] offset:9216
    ds_write_b128 v234, v[88:91] offset:10240
    ds_write_b128 v234, v[92:95] offset:11264
    s_mov_b32 exec_lo, 0
    s_nop 3
    v_mov_b32 v109, v155
    s_mov_b32 exec_lo, -1
    ds_write_b128 v234, v[96:99] offset:12288
    ds_write_b128 v234, v[100:103] offset:13312
    ds_write_b128 v234, v[104:107] offset:14336
    ds_write_b128 v234, v[108:111] offset:15360
    s_mov_b32 s50, 562036736
    s_mov_b32 s51, 1602224128
    s_mov_b64 s[52:53], -1
    v_cmp_lt_f32 vcc, s50, v60
    s_nop 0
    s_and_b64 s[52:53], s[52:53], vcc
    v_cmp_gt_f32 vcc, s51, v60
    s_nop 0
    s_and_b64 s[52:53], s[52:53], vcc
    v_cmp_lt_f32 vcc, s50, v76
    s_nop 0
    s_and_b64 s[52:53], s[52:53], vcc
    v_cmp_gt_f32 vcc, s51, v76
    s_nop 0
    s_and_b64 s[52:53], s[52:53], vcc
    v_cmp_lt_f32 vcc, s50, v92
    s_nop 0
    s_and_b64 s[52:53], s[52:53], vcc
    v_cmp_gt_f32 vcc, s51, v92
    s_nop 0
    s_and_b64 s[52:53], s[52:53], vcc
    v_cmp_lt_f32 vcc, s50, v108
    s_nop 0
    s_and_b64 s[52:53], s[52:53], vcc
    v_cmp_gt_f32 vcc, s51, v108
    s_nop 0
    s_and_b64 s[52:53], s[52:53], vcc
    s_cmp_eq_u32 s53, -1
    s_cbranch_scc0 FALLBACK
COMBINE:
    s_lshl_b32 s50, s40, 12
    v_add_u32 v5, s50, v1
    v_add_u32 v5, 90112, v5
    s_waitcnt lgkmcnt(0)
    s_barrier
    ds_read_b128 v[48:51], v5 offset:0
    ds_read_b128 v[52:55], v5 offset:1024
    ds_read_b128 v[56:59], v5 offset:2048
    ds_read_b128 v[60:63], v5 offset:3072
    ds_read_b128 v[64:67], v5 offset:16384
    ds_read_b128 v[68:71], v5 offset:17408
    ds_read_b128 v[72:75], v5 offset:18432
    ds_read_b128 v[76:79], v5 offset:19456
    ds_read_b128 v[80:83], v5 offset:32768
    ds_read_b128 v[84:87], v5 offset:33792
    ds_read_b128 v[88:91], v5 offset:34816
    ds_read_b128 v[92:95], v5 offset:35840
    ds_read_b128 v[96:99], v5 offset:49152
    ds_read_b128 v[100:103], v5 offset:50176
    ds_read_b128 v[104:107], v5 offset:51200
    ds_read_b128 v[108:111], v5 offset:52224
    s_waitcnt lgkmcnt(0)
    v_mov_b32 v156, v61
    v_mov_b32 v157, v61
    v_mov_b32 v158, v77
    v_mov_b32 v159, v77
    v_mov_b32 v160, v93
    v_mov_b32 v161, v93
    v_mov_b32 v162, v109
    v_mov_b32 v163, v109
    v_permlane32_swap_b32 v156, v157
    v_permlane32_swap_b32 v158, v159
    v_permlane32_swap_b32 v160, v161
    v_permlane32_swap_b32 v162, v163
    v_min3_f32 v156, v157, v159, v161
    v_min_f32 v156, v156, v163
    v_sub_f32 v157, v156, v157
    v_sub_f32 v159, v156, v159
    v_sub_f32 v161, v156, v161
    v_sub_f32 v163, v156, v163
    v_exp_f32 v157, v157
    v_exp_f32 v159, v159
    v_exp_f32 v161, v161
    v_exp_f32 v163, v163
    v_mul_f32 v48, v157, v48
    v_mul_f32 v49, v157, v49
    v_mul_f32 v50, v157, v50
    v_mul_f32 v51, v157, v51
    v_mul_f32 v52, v157, v52
    v_mul_f32 v53, v157, v53
    v_mul_f32 v54, v157, v54
    v_mul_f32 v55, v157, v55
    v_mul_f32 v56, v157, v56
    v_mul_f32 v57, v157, v57
    v_mul_f32 v58, v157, v58
    v_mul_f32 v59, v157, v59
    v_mul_f32 v60, v157, v60
    v_mul_f32 v61, v157, v61
    v_mul_f32 v62, v157, v62
    v_mul_f32 v63, v157, v63
    v_fmac_f32 v48, v159, v64
    v_fmac_f32 v49, v159, v65
    v_fmac_f32 v50, v159, v66
    v_fmac_f32 v51, v159, v67
    v_fmac_f32 v52, v159, v68
    v_fmac_f32 v53, v159, v69
    v_fmac_f32 v54, v159, v70
    v_fmac_f32 v55, v159, v71
    v_fmac_f32 v56, v159, v72
    v_fmac_f32 v57, v159, v73
    v_fmac_f32 v58, v159, v74
    v_fmac_f32 v59, v159, v75
    v_fmac_f32 v60, v159, v76
    v_fmac_f32 v61, v159, v77
    v_fmac_f32 v62, v159, v78
    v_fmac_f32 v63, v159, v79
    v_fmac_f32 v48, v161, v80
    v_fmac_f32 v49, v161, v81
    v_fmac_f32 v50, v161, v82
    v_fmac_f32 v51, v161, v83
    v_fmac_f32 v52, v161, v84
    v_fmac_f32 v53, v161, v85
    v_fmac_f32 v54, v161, v86
    v_fmac_f32 v55, v161, v87
    v_fmac_f32 v56, v161, v88
    v_fmac_f32 v57, v161, v89
    v_fmac_f32 v58, v161, v90
    v_fmac_f32 v59, v161, v91
    v_fmac_f32 v60, v161, v92
    v_fmac_f32 v61, v161, v93
    v_fmac_f32 v62, v161, v94
    v_fmac_f32 v63, v161, v95
    v_fmac_f32 v48, v163, v96
    v_fmac_f32 v49, v163, v97
    v_fmac_f32 v50, v163, v98
    v_fmac_f32 v51, v163, v99
    v_fmac_f32 v52, v163, v100
    v_fmac_f32 v53, v163, v101
    v_fmac_f32 v54, v163, v102
    v_fmac_f32 v55, v163, v103
    v_fmac_f32 v56, v163, v104
    v_fmac_f32 v57, v163, v105
    v_fmac_f32 v58, v163, v106
    v_fmac_f32 v59, v163, v107
    v_fmac_f32 v60, v163, v108
    v_fmac_f32 v61, v163, v109
    v_fmac_f32 v62, v163, v110
    v_fmac_f32 v63, v163, v111
    v_mov_b32 v164, v60
    v_mov_b32 v165, v60
    s_nop 1
    v_permlane32_swap_b32 v164, v165
    v_rcp_f32 v164, v165
    s_nop 0
    v_mul_f32 v48, v164, v48
    v_mul_f32 v49, v164, v49
    v_mul_f32 v50, v164, v50
    v_mul_f32 v51, v164, v51
    v_mul_f32 v52, v164, v52
    v_mul_f32 v53, v164, v53
    v_mul_f32 v54, v164, v54
    v_mul_f32 v55, v164, v55
    v_mul_f32 v56, v164, v56
    v_mul_f32 v57, v164, v57
    v_mul_f32 v58, v164, v58
    v_mul_f32 v59, v164, v59
    v_mul_f32 v60, v164, v60
    v_mul_f32 v61, v164, v61
    v_mul_f32 v62, v164, v62
    v_mul_f32 v63, v164, v63
    v_cvt_pk_bf16_f32 v166, v48, v49
    v_cvt_pk_bf16_f32 v167, v50, v51
    v_cvt_pk_bf16_f32 v168, v52, v53
    v_cvt_pk_bf16_f32 v169, v54, v55
    v_cvt_pk_bf16_f32 v170, v56, v57
    v_cvt_pk_bf16_f32 v171, v58, v59
    v_cvt_pk_bf16_f32 v172, v60, v61
    v_cvt_pk_bf16_f32 v173, v62, v63
    buffer_store_dwordx2 v[166:167], v2, s[16:19], s56 offen offset:0 sc1
    buffer_store_dwordx2 v[168:169], v2, s[16:19], s56 offen offset:512 sc1
    buffer_store_dwordx2 v[170:171], v2, s[16:19], s56 offen offset:1024 sc1
    s_mov_b32 exec_hi, 0
    buffer_store_dwordx2 v[172:173], v2, s[16:19], s56 offen offset:1536 sc1
    s_mov_b64 exec, -1
    v_mov_b32 v188, 157440
    v_mov_b32 v189, 1
    s_mov_b64 exec, 1
    ds_add_u32 v188, v189
    s_mov_b64 exec, -1
    s_lshl_b32 s50, s46, 2
    s_add_u32 s50, s50, s40
    s_lshl_b32 s50, s50, 4
    s_add_u32 s50, s50, s45
    s_lshl_b32 s50, s50, 6
    s_add_u32 s50, s50, 16908288
    v_mov_b32 v188, 0
    v_mov_b32 v189, s49
    s_waitcnt vmcnt(0)
    s_mov_b64 exec, 1
    buffer_store_dword v189, v188, s[16:19], s50 offen sc1
    s_mov_b64 exec, -1
    s_cmp_ge_u32 s42, 28
    s_cbranch_scc1 C_DONE
    s_barrier
    s_lshl_b32 s50, s47, 1
    s_mul_i32 s50, s50, 28672
    s_mul_i32 s51, s40, 7168
    s_add_u32 s50, s50, s51
    s_add_u32 s50, s50, 12582912
    s_add_u32 s52, s50, 4096
    s_add_u32 m0, s51, 57344
    s_nop 0
    buffer_load_dwordx4 v1, s[16:19], s50 offen offset:0 lds
    buffer_load_dwordx4 v1, s[16:19], s50 offen offset:1024 lds
    buffer_load_dwordx4 v1, s[16:19], s50 offen offset:2048 lds
    buffer_load_dwordx4 v1, s[16:19], s50 offen offset:3072 lds
    s_add_u32 m0, s51, 61440
    s_nop 0
    buffer_load_dwordx4 v1, s[16:19], s52 offen offset:0 lds
    buffer_load_dwordx4 v1, s[16:19], s52 offen offset:1024 lds
    buffer_load_dwordx4 v1, s[16:19], s52 offen offset:2048 lds
    s_waitcnt vmcnt(0)
    s_barrier
C_DONE:
    s_endpgm
GATE_WG:
    s_lshl_b32 s56, s3, 6
    s_lshl_b32 s50, s40, 4
    s_add_u32 s56, s56, s50
    s_mul_i32 s57, s56, 896
    v_mov_b32 v16, 0
    v_mov_b32 v17, 0
    v_mov_b32 v18, 0
    v_mov_b32 v19, 0
    v_mov_b32 v20, 0
    v_mov_b32 v21, 0
    v_mov_b32 v22, 0
    v_mov_b32 v23, 0
    v_mov_b32 v24, 0
    v_mov_b32 v25, 0
    v_mov_b32 v26, 0
    v_mov_b32 v27, 0
    v_mov_b32 v28, 0
    v_mov_b32 v29, 0
    v_mov_b32 v30, 0
    v_mov_b32 v31, 0
    v_mov_b32 v32, 0
    v_mov_b32 v33, 0
    v_mov_b32 v34, 0
    v_mov_b32 v35, 0
    v_mov_b32 v36, 0
    v_mov_b32 v37, 0
    v_mov_b32 v38, 0
    v_mov_b32 v39, 0
    v_mov_b32 v40, 0
    v_mov_b32 v41, 0
    v_mov_b32 v42, 0
    v_mov_b32 v43, 0
    v_mov_b32 v44, 0
    v_mov_b32 v45, 0
    v_mov_b32 v46, 0
    v_mov_b32 v47, 0
    v_mov_b32 v48, 0
    v_mov_b32 v49, 0
    v_mov_b32 v50, 0
    v_mov_b32 v51, 0
    v_mov_b32 v52, 0
    v_mov_b32 v53, 0
    v_mov_b32 v54, 0
    v_mov_b32 v55, 0
    v_mov_b32 v56, 0
    v_mov_b32 v57, 0
    v_mov_b32 v58, 0
    v_mov_b32 v59, 0
    v_mov_b32 v60, 0
    v_mov_b32 v61, 0
    v_mov_b32 v62, 0
    v_mov_b32 v63, 0
    v_mov_b32 v64, 0
    v_mov_b32 v65, 0
    v_mov_b32 v66, 0
    v_mov_b32 v67, 0
    v_mov_b32 v68, 0
    v_mov_b32 v69, 0
    v_mov_b32 v70, 0
    v_mov_b32 v71, 0
    v_mov_b32 v72, 0
    v_mov_b32 v73, 0
    v_mov_b32 v74, 0
    v_mov_b32 v75, 0
    v_mov_b32 v76, 0
    v_mov_b32 v77, 0
    v_mov_b32 v78, 0
    v_mov_b32 v79, 0
    v_mov_b32 v80, 0
    v_mov_b32 v81, 0
    v_mov_b32 v82, 0
    v_mov_b32 v83, 0
    s_mov_b32 exec_hi, 0x00ffffff
    buffer_load_dwordx4 v[80:83], v1, s[36:39], 0 offen
    s_add_u32 s50, s57, 0
    buffer_load_dwordx4 v[16:19], v1, s[4:7], s50 offen
    s_add_u32 s50, s57, 896
    buffer_load_dwordx4 v[20:23], v1, s[4:7], s50 offen
    s_add_u32 s50, s57, 1792
    buffer_load_dwordx4 v[24:27], v1, s[4:7], s50 offen
    s_add_u32 s50, s57, 2688
    buffer_load_dwordx4 v[28:31], v1, s[4:7], s50 offen
    s_add_u32 s50, s57, 3584
    buffer_load_dwordx4 v[32:35], v1, s[4:7], s50 offen
    s_add_u32 s50, s57, 4480
    buffer_load_dwordx4 v[36:39], v1, s[4:7], s50 offen
    s_add_u32 s50, s57, 5376
    buffer_load_dwordx4 v[40:43], v1, s[4:7], s50 offen
    s_add_u32 s50, s57, 6272
    buffer_load_dwordx4 v[44:47], v1, s[4:7], s50 offen
    s_add_u32 s50, s57, 7168
    buffer_load_dwordx4 v[48:51], v1, s[4:7], s50 offen
    s_add_u32 s50, s57, 8064
    buffer_load_dwordx4 v[52:55], v1, s[4:7], s50 offen
    s_add_u32 s50, s57, 8960
    buffer_load_dwordx4 v[56:59], v1, s[4:7], s50 offen
    s_add_u32 s50, s57, 9856
    buffer_load_dwordx4 v[60:63], v1, s[4:7], s50 offen
    s_add_u32 s50, s57, 10752
    buffer_load_dwordx4 v[64:67], v1, s[4:7], s50 offen
    s_add_u32 s50, s57, 11648
    buffer_load_dwordx4 v[68:71], v1, s[4:7], s50 offen
    s_add_u32 s50, s57, 12544
    buffer_load_dwordx4 v[72:75], v1, s[4:7], s50 offen
    s_add_u32 s50, s57, 13440
    buffer_load_dwordx4 v[76:79], v1, s[4:7], s50 offen
    s_mov_b64 exec, -1
    v_mov_b32 v84, 0
    v_mov_b32 v85, 0
    v_mov_b32 v86, 0
    v_mov_b32 v87, 0
    v_mov_b32 v88, 0
    v_mov_b32 v89, 0
    v_mov_b32 v90, 0
    v_mov_b32 v91, 0
    v_mov_b32 v92, 0
    v_mov_b32 v93, 0
    v_mov_b32 v94, 0
    v_mov_b32 v95, 0
    v_mov_b32 v96, 0
    v_mov_b32 v97, 0
    v_mov_b32 v98, 0
    v_mov_b32 v99, 0
    s_waitcnt vmcnt(0)
    v_dot2_f32_bf16 v84, v16, v80, v84
    v_dot2_f32_bf16 v85, v20, v80, v85
    v_dot2_f32_bf16 v86, v24, v80, v86
    v_dot2_f32_bf16 v87, v28, v80, v87
    v_dot2_f32_bf16 v88, v32, v80, v88
    v_dot2_f32_bf16 v89, v36, v80, v89
    v_dot2_f32_bf16 v90, v40, v80, v90
    v_dot2_f32_bf16 v91, v44, v80, v91
    v_dot2_f32_bf16 v92, v48, v80, v92
    v_dot2_f32_bf16 v93, v52, v80, v93
    v_dot2_f32_bf16 v94, v56, v80, v94
    v_dot2_f32_bf16 v95, v60, v80, v95
    v_dot2_f32_bf16 v96, v64, v80, v96
    v_dot2_f32_bf16 v97, v68, v80, v97
    v_dot2_f32_bf16 v98, v72, v80, v98
    v_dot2_f32_bf16 v99, v76, v80, v99
    v_dot2_f32_bf16 v84, v17, v81, v84
    v_dot2_f32_bf16 v85, v21, v81, v85
    v_dot2_f32_bf16 v86, v25, v81, v86
    v_dot2_f32_bf16 v87, v29, v81, v87
    v_dot2_f32_bf16 v88, v33, v81, v88
    v_dot2_f32_bf16 v89, v37, v81, v89
    v_dot2_f32_bf16 v90, v41, v81, v90
    v_dot2_f32_bf16 v91, v45, v81, v91
    v_dot2_f32_bf16 v92, v49, v81, v92
    v_dot2_f32_bf16 v93, v53, v81, v93
    v_dot2_f32_bf16 v94, v57, v81, v94
    v_dot2_f32_bf16 v95, v61, v81, v95
    v_dot2_f32_bf16 v96, v65, v81, v96
    v_dot2_f32_bf16 v97, v69, v81, v97
    v_dot2_f32_bf16 v98, v73, v81, v98
    v_dot2_f32_bf16 v99, v77, v81, v99
    v_dot2_f32_bf16 v84, v18, v82, v84
    v_dot2_f32_bf16 v85, v22, v82, v85
    v_dot2_f32_bf16 v86, v26, v82, v86
    v_dot2_f32_bf16 v87, v30, v82, v87
    v_dot2_f32_bf16 v88, v34, v82, v88
    v_dot2_f32_bf16 v89, v38, v82, v89
    v_dot2_f32_bf16 v90, v42, v82, v90
    v_dot2_f32_bf16 v91, v46, v82, v91
    v_dot2_f32_bf16 v92, v50, v82, v92
    v_dot2_f32_bf16 v93, v54, v82, v93
    v_dot2_f32_bf16 v94, v58, v82, v94
    v_dot2_f32_bf16 v95, v62, v82, v95
    v_dot2_f32_bf16 v96, v66, v82, v96
    v_dot2_f32_bf16 v97, v70, v82, v97
    v_dot2_f32_bf16 v98, v74, v82, v98
    v_dot2_f32_bf16 v99, v78, v82, v99
    v_dot2_f32_bf16 v84, v19, v83, v84
    v_dot2_f32_bf16 v85, v23, v83, v85
    v_dot2_f32_bf16 v86, v27, v83, v86
    v_dot2_f32_bf16 v87, v31, v83, v87
    v_dot2_f32_bf16 v88, v35, v83, v88
    v_dot2_f32_bf16 v89, v39, v83, v89
    v_dot2_f32_bf16 v90, v43, v83, v90
    v_dot2_f32_bf16 v91, v47, v83, v91
    v_dot2_f32_bf16 v92, v51, v83, v92
    v_dot2_f32_bf16 v93, v55, v83, v93
    v_dot2_f32_bf16 v94, v59, v83, v94
    v_dot2_f32_bf16 v95, v63, v83, v95
    v_dot2_f32_bf16 v96, v67, v83, v96
    v_dot2_f32_bf16 v97, v71, v83, v97
    v_dot2_f32_bf16 v98, v75, v83, v98
    v_dot2_f32_bf16 v99, v79, v83, v99
    s_nop 2
    v_add_f32_dpp v84, v84, v84 row_shr:1 row_mask:0xf bank_mask:0xf bound_ctrl:0
    v_add_f32_dpp v85, v85, v85 row_shr:1 row_mask:0xf bank_mask:0xf bound_ctrl:0
    v_add_f32_dpp v86, v86, v86 row_shr:1 row_mask:0xf bank_mask:0xf bound_ctrl:0
    v_add_f32_dpp v87, v87, v87 row_shr:1 row_mask:0xf bank_mask:0xf bound_ctrl:0
    v_add_f32_dpp v88, v88, v88 row_shr:1 row_mask:0xf bank_mask:0xf bound_ctrl:0
    v_add_f32_dpp v89, v89, v89 row_shr:1 row_mask:0xf bank_mask:0xf bound_ctrl:0
    v_add_f32_dpp v90, v90, v90 row_shr:1 row_mask:0xf bank_mask:0xf bound_ctrl:0
    v_add_f32_dpp v91, v91, v91 row_shr:1 row_mask:0xf bank_mask:0xf bound_ctrl:0
    v_add_f32_dpp v92, v92, v92 row_shr:1 row_mask:0xf bank_mask:0xf bound_ctrl:0
    v_add_f32_dpp v93, v93, v93 row_shr:1 row_mask:0xf bank_mask:0xf bound_ctrl:0
    v_add_f32_dpp v94, v94, v94 row_shr:1 row_mask:0xf bank_mask:0xf bound_ctrl:0
    v_add_f32_dpp v95, v95, v95 row_shr:1 row_mask:0xf bank_mask:0xf bound_ctrl:0
    v_add_f32_dpp v96, v96, v96 row_shr:1 row_mask:0xf bank_mask:0xf bound_ctrl:0
    v_add_f32_dpp v97, v97, v97 row_shr:1 row_mask:0xf bank_mask:0xf bound_ctrl:0
    v_add_f32_dpp v98, v98, v98 row_shr:1 row_mask:0xf bank_mask:0xf bound_ctrl:0
    v_add_f32_dpp v99, v99, v99 row_shr:1 row_mask:0xf bank_mask:0xf bound_ctrl:0
    v_add_f32_dpp v84, v84, v84 row_shr:2 row_mask:0xf bank_mask:0xf bound_ctrl:0
    v_add_f32_dpp v85, v85, v85 row_shr:2 row_mask:0xf bank_mask:0xf bound_ctrl:0
    v_add_f32_dpp v86, v86, v86 row_shr:2 row_mask:0xf bank_mask:0xf bound_ctrl:0
    v_add_f32_dpp v87, v87, v87 row_shr:2 row_mask:0xf bank_mask:0xf bound_ctrl:0
    v_add_f32_dpp v88, v88, v88 row_shr:2 row_mask:0xf bank_mask:0xf bound_ctrl:0
    v_add_f32_dpp v89, v89, v89 row_shr:2 row_mask:0xf bank_mask:0xf bound_ctrl:0
    v_add_f32_dpp v90, v90, v90 row_shr:2 row_mask:0xf bank_mask:0xf bound_ctrl:0
    v_add_f32_dpp v91, v91, v91 row_shr:2 row_mask:0xf bank_mask:0xf bound_ctrl:0
    v_add_f32_dpp v92, v92, v92 row_shr:2 row_mask:0xf bank_mask:0xf bound_ctrl:0
    v_add_f32_dpp v93, v93, v93 row_shr:2 row_mask:0xf bank_mask:0xf bound_ctrl:0
    v_add_f32_dpp v94, v94, v94 row_shr:2 row_mask:0xf bank_mask:0xf bound_ctrl:0
    v_add_f32_dpp v95, v95, v95 row_shr:2 row_mask:0xf bank_mask:0xf bound_ctrl:0
    v_add_f32_dpp v96, v96, v96 row_shr:2 row_mask:0xf bank_mask:0xf bound_ctrl:0
    v_add_f32_dpp v97, v97, v97 row_shr:2 row_mask:0xf bank_mask:0xf bound_ctrl:0
    v_add_f32_dpp v98, v98, v98 row_shr:2 row_mask:0xf bank_mask:0xf bound_ctrl:0
    v_add_f32_dpp v99, v99, v99 row_shr:2 row_mask:0xf bank_mask:0xf bound_ctrl:0
    v_add_f32_dpp v84, v84, v84 row_shr:4 row_mask:0xf bank_mask:0xf bound_ctrl:0
    v_add_f32_dpp v85, v85, v85 row_shr:4 row_mask:0xf bank_mask:0xf bound_ctrl:0
    v_add_f32_dpp v86, v86, v86 row_shr:4 row_mask:0xf bank_mask:0xf bound_ctrl:0
    v_add_f32_dpp v87, v87, v87 row_shr:4 row_mask:0xf bank_mask:0xf bound_ctrl:0
    v_add_f32_dpp v88, v88, v88 row_shr:4 row_mask:0xf bank_mask:0xf bound_ctrl:0
    v_add_f32_dpp v89, v89, v89 row_shr:4 row_mask:0xf bank_mask:0xf bound_ctrl:0
    v_add_f32_dpp v90, v90, v90 row_shr:4 row_mask:0xf bank_mask:0xf bound_ctrl:0
    v_add_f32_dpp v91, v91, v91 row_shr:4 row_mask:0xf bank_mask:0xf bound_ctrl:0
    v_add_f32_dpp v92, v92, v92 row_shr:4 row_mask:0xf bank_mask:0xf bound_ctrl:0
    v_add_f32_dpp v93, v93, v93 row_shr:4 row_mask:0xf bank_mask:0xf bound_ctrl:0
    v_add_f32_dpp v94, v94, v94 row_shr:4 row_mask:0xf bank_mask:0xf bound_ctrl:0
    v_add_f32_dpp v95, v95, v95 row_shr:4 row_mask:0xf bank_mask:0xf bound_ctrl:0
    v_add_f32_dpp v96, v96, v96 row_shr:4 row_mask:0xf bank_mask:0xf bound_ctrl:0
    v_add_f32_dpp v97, v97, v97 row_shr:4 row_mask:0xf bank_mask:0xf bound_ctrl:0
    v_add_f32_dpp v98, v98, v98 row_shr:4 row_mask:0xf bank_mask:0xf bound_ctrl:0
    v_add_f32_dpp v99, v99, v99 row_shr:4 row_mask:0xf bank_mask:0xf bound_ctrl:0
    v_add_f32_dpp v84, v84, v84 row_shr:8 row_mask:0xf bank_mask:0xf bound_ctrl:0
    v_add_f32_dpp v85, v85, v85 row_shr:8 row_mask:0xf bank_mask:0xf bound_ctrl:0
    v_add_f32_dpp v86, v86, v86 row_shr:8 row_mask:0xf bank_mask:0xf bound_ctrl:0
    v_add_f32_dpp v87, v87, v87 row_shr:8 row_mask:0xf bank_mask:0xf bound_ctrl:0
    v_add_f32_dpp v88, v88, v88 row_shr:8 row_mask:0xf bank_mask:0xf bound_ctrl:0
    v_add_f32_dpp v89, v89, v89 row_shr:8 row_mask:0xf bank_mask:0xf bound_ctrl:0
    v_add_f32_dpp v90, v90, v90 row_shr:8 row_mask:0xf bank_mask:0xf bound_ctrl:0
    v_add_f32_dpp v91, v91, v91 row_shr:8 row_mask:0xf bank_mask:0xf bound_ctrl:0
    v_add_f32_dpp v92, v92, v92 row_shr:8 row_mask:0xf bank_mask:0xf bound_ctrl:0
    v_add_f32_dpp v93, v93, v93 row_shr:8 row_mask:0xf bank_mask:0xf bound_ctrl:0
    v_add_f32_dpp v94, v94, v94 row_shr:8 row_mask:0xf bank_mask:0xf bound_ctrl:0
    v_add_f32_dpp v95, v95, v95 row_shr:8 row_mask:0xf bank_mask:0xf bound_ctrl:0
    v_add_f32_dpp v96, v96, v96 row_shr:8 row_mask:0xf bank_mask:0xf bound_ctrl:0
    v_add_f32_dpp v97, v97, v97 row_shr:8 row_mask:0xf bank_mask:0xf bound_ctrl:0
    v_add_f32_dpp v98, v98, v98 row_shr:8 row_mask:0xf bank_mask:0xf bound_ctrl:0
    v_add_f32_dpp v99, v99, v99 row_shr:8 row_mask:0xf bank_mask:0xf bound_ctrl:0
    v_add_f32_dpp v84, v84, v84 row_bcast:15 row_mask:0xa bank_mask:0xf
    v_add_f32_dpp v85, v85, v85 row_bcast:15 row_mask:0xa bank_mask:0xf
    v_add_f32_dpp v86, v86, v86 row_bcast:15 row_mask:0xa bank_mask:0xf
    v_add_f32_dpp v87, v87, v87 row_bcast:15 row_mask:0xa bank_mask:0xf
    v_add_f32_dpp v88, v88, v88 row_bcast:15 row_mask:0xa bank_mask:0xf
    v_add_f32_dpp v89, v89, v89 row_bcast:15 row_mask:0xa bank_mask:0xf
    v_add_f32_dpp v90, v90, v90 row_bcast:15 row_mask:0xa bank_mask:0xf
    v_add_f32_dpp v91, v91, v91 row_bcast:15 row_mask:0xa bank_mask:0xf
    v_add_f32_dpp v92, v92, v92 row_bcast:15 row_mask:0xa bank_mask:0xf
    v_add_f32_dpp v93, v93, v93 row_bcast:15 row_mask:0xa bank_mask:0xf
    v_add_f32_dpp v94, v94, v94 row_bcast:15 row_mask:0xa bank_mask:0xf
    v_add_f32_dpp v95, v95, v95 row_bcast:15 row_mask:0xa bank_mask:0xf
    v_add_f32_dpp v96, v96, v96 row_bcast:15 row_mask:0xa bank_mask:0xf
    v_add_f32_dpp v97, v97, v97 row_bcast:15 row_mask:0xa bank_mask:0xf
    v_add_f32_dpp v98, v98, v98 row_bcast:15 row_mask:0xa bank_mask:0xf
    v_add_f32_dpp v99, v99, v99 row_bcast:15 row_mask:0xa bank_mask:0xf
    v_add_f32_dpp v84, v84, v84 row_bcast:31 row_mask:0xc bank_mask:0xf
    v_add_f32_dpp v85, v85, v85 row_bcast:31 row_mask:0xc bank_mask:0xf
    v_add_f32_dpp v86, v86, v86 row_bcast:31 row_mask:0xc bank_mask:0xf
    v_add_f32_dpp v87, v87, v87 row_bcast:31 row_mask:0xc bank_mask:0xf
    v_add_f32_dpp v88, v88, v88 row_bcast:31 row_mask:0xc bank_mask:0xf
    v_add_f32_dpp v89, v89, v89 row_bcast:31 row_mask:0xc bank_mask:0xf
    v_add_f32_dpp v90, v90, v90 row_bcast:31 row_mask:0xc bank_mask:0xf
    v_add_f32_dpp v91, v91, v91 row_bcast:31 row_mask:0xc bank_mask:0xf
    v_add_f32_dpp v92, v92, v92 row_bcast:31 row_mask:0xc bank_mask:0xf
    v_add_f32_dpp v93, v93, v93 row_bcast:31 row_mask:0xc bank_mask:0xf
    v_add_f32_dpp v94, v94, v94 row_bcast:31 row_mask:0xc bank_mask:0xf
    v_add_f32_dpp v95, v95, v95 row_bcast:31 row_mask:0xc bank_mask:0xf
    v_add_f32_dpp v96, v96, v96 row_bcast:31 row_mask:0xc bank_mask:0xf
    v_add_f32_dpp v97, v97, v97 row_bcast:31 row_mask:0xc bank_mask:0xf
    v_add_f32_dpp v98, v98, v98 row_bcast:31 row_mask:0xc bank_mask:0xf
    v_add_f32_dpp v99, v99, v99 row_bcast:31 row_mask:0xc bank_mask:0xf
    v_cvt_pk_bf16_f32 v16, v84, v85
    v_lshlrev_b32 v84, 16, v16
    v_and_b32 v85, 0xffff0000, v16
    v_cvt_pk_bf16_f32 v16, v86, v87
    v_lshlrev_b32 v86, 16, v16
    v_and_b32 v87, 0xffff0000, v16
    v_cvt_pk_bf16_f32 v16, v88, v89
    v_lshlrev_b32 v88, 16, v16
    v_and_b32 v89, 0xffff0000, v16
    v_cvt_pk_bf16_f32 v16, v90, v91
    v_lshlrev_b32 v90, 16, v16
    v_and_b32 v91, 0xffff0000, v16
    v_cvt_pk_bf16_f32 v16, v92, v93
    v_lshlrev_b32 v92, 16, v16
    v_and_b32 v93, 0xffff0000, v16
    v_cvt_pk_bf16_f32 v16, v94, v95
    v_lshlrev_b32 v94, 16, v16
    v_and_b32 v95, 0xffff0000, v16
    v_cvt_pk_bf16_f32 v16, v96, v97
    v_lshlrev_b32 v96, 16, v16
    v_and_b32 v97, 0xffff0000, v16
    v_cvt_pk_bf16_f32 v16, v98, v99
    v_lshlrev_b32 v98, 16, v16
    v_and_b32 v99, 0xffff0000, v16
    v_mul_f32 v84, 3216550459, v84
    v_mul_f32 v85, 3216550459, v85
    v_mul_f32 v86, 3216550459, v86
    v_mul_f32 v87, 3216550459, v87
    v_mul_f32 v88, 3216550459, v88
    v_mul_f32 v89, 3216550459, v89
    v_mul_f32 v90, 3216550459, v90
    v_mul_f32 v91, 3216550459, v91
    v_mul_f32 v92, 3216550459, v92
    v_mul_f32 v93, 3216550459, v93
    v_mul_f32 v94, 3216550459, v94
    v_mul_f32 v95, 3216550459, v95
    v_mul_f32 v96, 3216550459, v96
    v_mul_f32 v97, 3216550459, v97
    v_mul_f32 v98, 3216550459, v98
    v_mul_f32 v99, 3216550459, v99
    v_exp_f32 v84, v84
    v_exp_f32 v85, v85
    v_exp_f32 v86, v86
    v_exp_f32 v87, v87
    v_exp_f32 v88, v88
    v_exp_f32 v89, v89
    v_exp_f32 v90, v90
    v_exp_f32 v91, v91
    v_exp_f32 v92, v92
    v_exp_f32 v93, v93
    v_exp_f32 v94, v94
    v_exp_f32 v95, v95
    v_exp_f32 v96, v96
    v_exp_f32 v97, v97
    v_exp_f32 v98, v98
    v_exp_f32 v99, v99
    v_add_f32 v84, 1.0, v84
    v_add_f32 v85, 1.0, v85
    v_add_f32 v86, 1.0, v86
    v_add_f32 v87, 1.0, v87
    v_add_f32 v88, 1.0, v88
    v_add_f32 v89, 1.0, v89
    v_add_f32 v90, 1.0, v90
    v_add_f32 v91, 1.0, v91
    v_add_f32 v92, 1.0, v92
    v_add_f32 v93, 1.0, v93
    v_add_f32 v94, 1.0, v94
    v_add_f32 v95, 1.0, v95
    v_add_f32 v96, 1.0, v96
    v_add_f32 v97, 1.0, v97
    v_add_f32 v98, 1.0, v98
    v_add_f32 v99, 1.0, v99
    v_rcp_f32 v84, v84
    v_rcp_f32 v85, v85
    v_rcp_f32 v86, v86
    v_rcp_f32 v87, v87
    v_rcp_f32 v88, v88
    v_rcp_f32 v89, v89
    v_rcp_f32 v90, v90
    v_rcp_f32 v91, v91
    v_rcp_f32 v92, v92
    v_rcp_f32 v93, v93
    v_rcp_f32 v94, v94
    v_rcp_f32 v95, v95
    v_rcp_f32 v96, v96
    v_rcp_f32 v97, v97
    v_rcp_f32 v98, v98
    v_rcp_f32 v99, v99
    v_cvt_pk_bf16_f32 v16, v84, v85
    v_lshlrev_b32 v84, 16, v16
    v_and_b32 v85, 0xffff0000, v16
    v_cvt_pk_bf16_f32 v16, v86, v87
    v_lshlrev_b32 v86, 16, v16
    v_and_b32 v87, 0xffff0000, v16
    v_cvt_pk_bf16_f32 v16, v88, v89
    v_lshlrev_b32 v88, 16, v16
    v_and_b32 v89, 0xffff0000, v16
    v_cvt_pk_bf16_f32 v16, v90, v91
    v_lshlrev_b32 v90, 16, v16
    v_and_b32 v91, 0xffff0000, v16
    v_cvt_pk_bf16_f32 v16, v92, v93
    v_lshlrev_b32 v92, 16, v16
    v_and_b32 v93, 0xffff0000, v16
    v_cvt_pk_bf16_f32 v16, v94, v95
    v_lshlrev_b32 v94, 16, v16
    v_and_b32 v95, 0xffff0000, v16
    v_cvt_pk_bf16_f32 v16, v96, v97
    v_lshlrev_b32 v96, 16, v16
    v_and_b32 v97, 0xffff0000, v16
    v_cvt_pk_bf16_f32 v16, v98, v99
    v_lshlrev_b32 v98, 16, v16
    v_and_b32 v99, 0xffff0000, v16
    s_lshl_b32 s50, s56, 2
    s_add_u32 s50, s50, 16777216
    v_mov_b32 v16, 0
    s_mov_b32 exec_lo, 0
    s_mov_b32 exec_hi, 0x80000000
    buffer_store_dwordx4 v[84:87], v16, s[16:19], s50 offen offset:0 sc1
    buffer_store_dwordx4 v[88:91], v16, s[16:19], s50 offen offset:16 sc1
    buffer_store_dwordx4 v[92:95], v16, s[16:19], s50 offen offset:32 sc1
    buffer_store_dwordx4 v[96:99], v16, s[16:19], s50 offen offset:48 sc1
    s_mov_b64 exec, -1
    s_waitcnt vmcnt(0)
    s_barrier
    v_mov_b32 v188, 0
    s_mov_b32 s51, 0
NON_37:
    buffer_load_dword v189, v188, s[32:35], 0 offen sc1
    s_waitcnt vmcnt(0)
    v_readfirstlane_b32 s49, v189
    s_nop 0
    s_cmp_lg_u32 s49, 0
    s_cbranch_scc1 NOND_38
    s_sleep 4
    s_add_u32 s51, s51, 1
    s_cmp_lt_u32 s51, 40000
    s_cbranch_scc1 NON_37
NOND_38:
    s_lshl_b32 s50, s2, 6
    s_add_u32 s50, s50, 16842752
    v_mov_b32 v188, 0
    v_mov_b32 v189, s49
    s_mov_b64 exec, 1
    s_cmp_lg_u32 s40, 0
    s_cbranch_scc1 PUB_39
    buffer_store_dword v189, v188, s[16:19], s50 offen sc1
PUB_39:
    s_mov_b64 exec, -1
    s_barrier
    s_branch ATT_C_ENTRY
GATE_H:
    s_setprio 1
    s_waitcnt lgkmcnt(0)
    s_mov_b32 s4, s68
    s_and_b32 s5, s69, 0xffff
    s_mov_b32 s6, 1835008
    s_mov_b32 s7, 0x20000
    s_mov_b32 s8, s70
    s_and_b32 s9, s71, 0xffff
    s_mov_b32 s10, 1204224
    s_mov_b32 s11, 0x20000
    s_mov_b32 s20, s72
    s_and_b32 s21, s73, 0xffff
    s_mov_b32 s22, 401408
    s_mov_b32 s23, 0x20000
    s_mov_b32 s12, s76
    s_and_b32 s13, s77, 0xffff
    s_mov_b32 s14, 1204224
    s_mov_b32 s15, 0x20000
    s_mov_b32 s24, s78
    s_and_b32 s25, s79, 0xffff
    s_mov_b32 s26, 401408
    s_mov_b32 s27, 0x20000
    s_mov_b32 s36, s80
    s_and_b32 s37, s81, 0xffff
    s_mov_b32 s38, 896
    s_mov_b32 s39, 0x20000
    s_mov_b32 s28, s82
    s_and_b32 s29, s83, 0xffff
    s_mov_b32 s30, 1835008
    s_mov_b32 s31, 0x20000
    s_mov_b32 s32, s84
    s_and_b32 s33, s85, 0xffff
    s_mov_b32 s34, 256
    s_mov_b32 s35, 0x20000
    s_mov_b32 s16, s86
    s_and_b32 s17, s87, 0xffff
    s_mov_b32 s18, 16973824
    s_mov_b32 s19, 0x20000
    s_lshl_b32 s45, s41, 1
    s_and_b32 s50, s42, 1
    s_add_u32 s45, s45, s50
    s_lshr_b32 s46, s2, 4
    s_lshl_b32 s47, s41, 2
    s_and_b32 s50, s42, 3
    s_add_u32 s47, s47, s50
    s_lshr_b32 s48, s42, 2
    s_sub_u32 s56, s42, 28
    s_lshl_b32 s56, s56, 2
    s_add_u32 s56, s56, s40
    s_sub_u32 s56, s56, 4
    s_lshr_b32 s50, s41, 1
    s_mul_i32 s57, s50, 458752
    s_mul_i32 s50, s56, 28672
    s_add_u32 s57, s57, s50
    v_and_b32 v2, 31, v0
    v_lshlrev_b32 v2, 4, v2
    v_lshrrev_b32 v3, 5, v0
    s_movk_i32 s50, 896
    v_mad_u32_u24 v4, v3, s50, v2
    v_add_u32 v5, 1792, v4
    v_add_u32 v6, 3584, v4
    s_and_b32 s50, s41, 1
    s_mul_i32 s58, s50, 384
    s_mul_i32 s50, s56, 5376
    s_add_u32 s58, s58, s50
    s_lshl_b32 s59, s56, 10
    s_add_u32 s50, s58, 0
    buffer_load_dwordx4 v[20:23], v4, s[12:15], s50 offen
    buffer_load_dwordx4 v[24:27], v5, s[12:15], s50 offen
    buffer_load_dwordx4 v[28:31], v6, s[12:15], s50 offen
    s_add_u32 s50, s58, 86016
    buffer_load_dwordx4 v[32:35], v4, s[12:15], s50 offen
    buffer_load_dwordx4 v[36:39], v5, s[12:15], s50 offen
    buffer_load_dwordx4 v[40:43], v6, s[12:15], s50 offen
    s_add_u32 s50, s58, 172032
    buffer_load_dwordx4 v[44:47], v4, s[12:15], s50 offen
    buffer_load_dwordx4 v[48:51], v5, s[12:15], s50 offen
    buffer_load_dwordx4 v[52:55], v6, s[12:15], s50 offen
    s_add_u32 s50, s58, 258048
    buffer_load_dwordx4 v[56:59], v4, s[12:15], s50 offen
    buffer_load_dwordx4 v[60:63], v5, s[12:15], s50 offen
    buffer_load_dwordx4 v[64:67], v6, s[12:15], s50 offen
    s_add_u32 s50, s58, 344064
    buffer_load_dwordx4 v[68:71], v4, s[12:15], s50 offen
    buffer_load_dwordx4 v[72:75], v5, s[12:15], s50 offen
    buffer_load_dwordx4 v[76:79], v6, s[12:15], s50 offen
    s_add_u32 s50, s58, 430080
    buffer_load_dwordx4 v[80:83], v4, s[12:15], s50 offen
    buffer_load_dwordx4 v[84:87], v5, s[12:15], s50 offen
    buffer_load_dwordx4 v[88:91], v6, s[12:15], s50 offen
    s_add_u32 s50, s58, 516096
    buffer_load_dwordx4 v[92:95], v4, s[12:15], s50 offen
    buffer_load_dwordx4 v[96:99], v5, s[12:15], s50 offen
    buffer_load_dwordx4 v[100:103], v6, s[12:15], s50 offen
    s_add_u32 s50, s58, 602112
    buffer_load_dwordx4 v[104:107], v4, s[12:15], s50 offen
    buffer_load_dwordx4 v[108:111], v5, s[12:15], s50 offen
    buffer_load_dwordx4 v[112:115], v6, s[12:15], s50 offen
    s_add_u32 s50, s58, 688128
    buffer_load_dwordx4 v[116:119], v4, s[12:15], s50 offen
    buffer_load_dwordx4 v[120:123], v5, s[12:15], s50 offen
    buffer_load_dwordx4 v[124:127], v6, s[12:15], s50 offen
    s_add_u32 s50, s58, 774144
    buffer_load_dwordx4 v[128:131], v4, s[12:15], s50 offen
    buffer_load_dwordx4 v[132:135], v5, s[12:15], s50 offen
    buffer_load_dwordx4 v[136:139], v6, s[12:15], s50 offen
    s_add_u32 s50, s58, 860160
    buffer_load_dwordx4 v[140:143], v4, s[12:15], s50 offen
    buffer_load_dwordx4 v[16:19], v5, s[12:15], s50 offen
    buffer_load_dwordx4 v[20:23], v6, s[12:15], s50 offen
    s_add_u32 s50, s58, 946176
    buffer_load_dwordx4 v[24:27], v4, s[12:15], s50 offen
    buffer_load_dwordx4 v[28:31], v5, s[12:15], s50 offen
    buffer_load_dwordx4 v[32:35], v6, s[12:15], s50 offen
    s_add_u32 s50, s58, 1032192
    buffer_load_dwordx4 v[36:39], v4, s[12:15], s50 offen
    buffer_load_dwordx4 v[40:43], v5, s[12:15], s50 offen
    buffer_load_dwordx4 v[44:47], v6, s[12:15], s50 offen
    s_add_u32 s50, s58, 1118208
    buffer_load_dwordx4 v[48:51], v4, s[12:15], s50 offen
    buffer_load_dwordx4 v[52:55], v5, s[12:15], s50 offen
    buffer_load_dwordx4 v[56:59], v6, s[12:15], s50 offen
    s_barrier
    v_mov_b32 v12, 0
    s_mov_b32 s51, 0
NON_41:
    buffer_load_dword v13, v12, s[32:35], 0 offen sc1
    s_waitcnt vmcnt(0)
    v_readfirstlane_b32 s49, v13
    s_nop 0
    s_cmp_lg_u32 s49, 0
    s_cbranch_scc1 NOND_42
    s_sleep 4
    s_add_u32 s51, s51, 1
    s_cmp_lt_u32 s51, 40000
    s_cbranch_scc1 NON_41
NOND_42:
    s_mov_b32 s63, 0
    s_waitcnt vmcnt(0)
    s_cmp_lg_u32 s40, 4
    s_cbranch_scc1 POLLD_44
    s_mov_b32 s50, 16842752
    s_mov_b32 s92, 16846848
    s_mov_b32 s93, 16850944
    s_mov_b32 s94, 16855040
    v_lshlrev_b32 v11, 6, v0
    s_mov_b32 s51, 0
    s_mov_b64 s[52:53], -1
    s_mov_b64 s[54:55], -1
    s_mov_b64 s[88:89], -1
    s_mov_b64 s[90:91], -1
POLL_43:
    s_mov_b64 exec, s[52:53]
    s_cbranch_execz PSK_45
    buffer_load_dword v12, v11, s[16:19], s50 offen sc1
PSK_45:
    s_mov_b64 exec, s[54:55]
    s_cbranch_execz PSK_46
    buffer_load_dword v13, v11, s[16:19], s92 offen sc1
PSK_46:
    s_mov_b64 exec, s[88:89]
    s_cbranch_execz PSK_47
    buffer_load_dword v14, v11, s[16:19], s93 offen sc1
PSK_47:
    s_mov_b64 exec, s[90:91]
    s_cbranch_execz PSK_48
    buffer_load_dword v15, v11, s[16:19], s94 offen sc1
PSK_48:
    s_waitcnt vmcnt(0)
    s_mov_b64 exec, s[52:53]
    v_cmp_ne_u32 s[52:53], s49, v12
    s_mov_b64 exec, s[54:55]
    v_cmp_ne_u32 s[54:55], s49, v13
    s_mov_b64 exec, s[88:89]
    v_cmp_ne_u32 s[88:89], s49, v14
    s_mov_b64 exec, s[90:91]
    v_cmp_ne_u32 s[90:91], s49, v15
    s_mov_b64 exec, -1
    s_or_b64 vcc, s[52:53], s[54:55]
    s_or_b64 vcc, vcc, s[88:89]
    s_or_b64 vcc, vcc, s[90:91]
    s_cmp_eq_u64 vcc, 0
    s_cbranch_scc1 POLLD_44
    s_sleep 4
    s_add_u32 s51, s51, 1
    s_cmp_lt_u32 s51, 40000
    s_cbranch_scc1 POLL_43
POLLD_44:
    s_barrier
    s_branch ATT_H_ENTRY
FALLBACK:
    s_nop 15
    v_and_b32 v5, 31, v0
    v_lshrrev_b32 v6, 5, v0
    v_lshlrev_b32 v5, 4, v5
    s_movk_i32 s50, 7168
    v_mad_u32_u24 v5, v6, s50, v5
    s_lshl_b32 s57, s40, 4
    s_mul_i32 s57, s57, 28672
    s_mul_i32 s50, s45, 1792
    s_add_u32 s58, s57, s50
    s_add_u32 s58, s58, 2097152
    s_mul_i32 s50, s45, 448
    s_add_u32 s59, s57, s50
    s_add_u32 s59, s59, 4194304
    s_mov_b32 exec_lo, 0
    v_mov_b32 v198, 0
    v_mov_b32 v206, 0
    v_mov_b32 v214, 0
    v_mov_b32 v222, 0
    v_mov_b32 v22, 0
    v_mov_b32 v23, 0
    s_mov_b32 exec_lo, -1
    v_mov_b32 v24, 0
    v_mov_b32 v25, 0
    v_mov_b32 v26, 0
    v_mov_b32 v27, 0
    v_mov_b32 v28, 0
    v_mov_b32 v29, 0
    v_mov_b32 v30, 0
    v_mov_b32 v31, 0
    s_mov_b32 exec_lo, 0x10000000
    s_mov_b32 exec_hi, 0x10000000
    v_mov_b32 v24, 0x3f803f80
    v_mov_b32 v25, 0x3f803f80
    v_mov_b32 v26, 0x3f803f80
    v_mov_b32 v27, 0x3f803f80
    v_mov_b32 v28, 0x3f803f80
    v_mov_b32 v29, 0x3f803f80
    v_mov_b32 v30, 0x3f803f80
    v_mov_b32 v31, 0x3f803f80
    s_mov_b64 exec, -1
    v_mov_b32 v152, 2137108966
    v_mov_b32 v48, 0
    v_mov_b32 v49, 0
    v_mov_b32 v50, 0
    v_mov_b32 v51, 0
    v_mov_b32 v52, 0
    v_mov_b32 v53, 0
    v_mov_b32 v54, 0
    v_mov_b32 v55, 0
    v_mov_b32 v56, 0
    v_mov_b32 v57, 0
    v_mov_b32 v58, 0
    v_mov_b32 v59, 0
    v_mov_b32 v60, 0
    v_mov_b32 v61, 0
    v_mov_b32 v62, 0
    v_mov_b32 v63, 0
    v_mov_b32 v153, 2137108966
    v_mov_b32 v64, 0
    v_mov_b32 v65, 0
    v_mov_b32 v66, 0
    v_mov_b32 v67, 0
    v_mov_b32 v68, 0
    v_mov_b32 v69, 0
    v_mov_b32 v70, 0
    v_mov_b32 v71, 0
    v_mov_b32 v72, 0
    v_mov_b32 v73, 0
    v_mov_b32 v74, 0
    v_mov_b32 v75, 0
    v_mov_b32 v76, 0
    v_mov_b32 v77, 0
    v_mov_b32 v78, 0
    v_mov_b32 v79, 0
    v_mov_b32 v154, 2137108966
    v_mov_b32 v80, 0
    v_mov_b32 v81, 0
    v_mov_b32 v82, 0
    v_mov_b32 v83, 0
    v_mov_b32 v84, 0
    v_mov_b32 v85, 0
    v_mov_b32 v86, 0
    v_mov_b32 v87, 0
    v_mov_b32 v88, 0
    v_mov_b32 v89, 0
    v_mov_b32 v90, 0
    v_mov_b32 v91, 0
    v_mov_b32 v92, 0
    v_mov_b32 v93, 0
    v_mov_b32 v94, 0
    v_mov_b32 v95, 0
    v_mov_b32 v155, 2137108966
    v_mov_b32 v96, 0
    v_mov_b32 v97, 0
    v_mov_b32 v98, 0
    v_mov_b32 v99, 0
    v_mov_b32 v100, 0
    v_mov_b32 v101, 0
    v_mov_b32 v102, 0
    v_mov_b32 v103, 0
    v_mov_b32 v104, 0
    v_mov_b32 v105, 0
    v_mov_b32 v106, 0
    v_mov_b32 v107, 0
    v_mov_b32 v108, 0
    v_mov_b32 v109, 0
    v_mov_b32 v110, 0
    v_mov_b32 v111, 0
    s_mov_b32 s57, 0
FB_LOOP:
    buffer_load_dwordx2 v[16:17], v224, s[16:19], s58 offen offset:0
    buffer_load_dwordx2 v[18:19], v224, s[16:19], s58 offen offset:512
    buffer_load_dwordx2 v[20:21], v224, s[16:19], s58 offen offset:1024
    s_mov_b32 exec_hi, 0
    buffer_load_dwordx2 v[22:23], v224, s[16:19], s58 offen offset:1536
    s_mov_b32 exec_hi, -1
    s_add_u32 s50, s59, 14336
    s_mov_b32 exec_lo, 0x0fffffff
    s_mov_b32 exec_hi, 0x0fffffff
    buffer_load_dwordx4 v[24:27], v5, s[16:19], s59 offen
    buffer_load_dwordx4 v[28:31], v5, s[16:19], s50 offen
    s_mov_b64 exec, -1
    s_waitcnt vmcnt(0)
    v_mfma_f32_32x32x16_bf16 v[112:127], v[16:19], v[192:195], 0
    v_mfma_f32_32x32x16_bf16 v[112:127], v[20:23], v[196:199], v[112:127]
    s_nop 11
    v_max3_f32 v156, v112, v113, v114
    v_max3_f32 v156, v156, v115, v116
    v_max3_f32 v156, v156, v117, v118
    v_max_f32 v156, v156, v119
    v_max3_f32 v157, v120, v121, v122
    v_max3_f32 v157, v157, v123, v124
    v_max3_f32 v157, v157, v125, v126
    v_max_f32 v157, v157, v127
    v_max_f32 v156, v156, v157
    v_mov_b32 v157, v156
    s_nop 1
    v_permlane32_swap_b32 v156, v157
    v_max_f32 v156, v156, v157
    v_min_f32 v157, v152, -v156
    v_sub_f32 v158, v157, v152
    v_exp_f32 v158, v158
    v_mov_b32 v152, v157
    v_add_f32 v112, v112, v157
    v_add_f32 v113, v113, v157
    v_add_f32 v114, v114, v157
    v_add_f32 v115, v115, v157
    v_add_f32 v116, v116, v157
    v_add_f32 v117, v117, v157
    v_add_f32 v118, v118, v157
    v_add_f32 v119, v119, v157
    v_add_f32 v120, v120, v157
    v_add_f32 v121, v121, v157
    v_add_f32 v122, v122, v157
    v_add_f32 v123, v123, v157
    v_add_f32 v124, v124, v157
    v_add_f32 v125, v125, v157
    v_add_f32 v126, v126, v157
    v_add_f32 v127, v127, v157
    v_exp_f32 v112, v112
    v_exp_f32 v113, v113
    v_exp_f32 v114, v114
    v_exp_f32 v115, v115
    v_exp_f32 v116, v116
    v_exp_f32 v117, v117
    v_exp_f32 v118, v118
    v_exp_f32 v119, v119
    v_exp_f32 v120, v120
    v_exp_f32 v121, v121
    v_exp_f32 v122, v122
    v_exp_f32 v123, v123
    v_exp_f32 v124, v124
    v_exp_f32 v125, v125
    v_exp_f32 v126, v126
    v_exp_f32 v127, v127
    v_mul_f32 v48, v158, v48
    v_mul_f32 v49, v158, v49
    v_mul_f32 v50, v158, v50
    v_mul_f32 v51, v158, v51
    v_mul_f32 v52, v158, v52
    v_mul_f32 v53, v158, v53
    v_mul_f32 v54, v158, v54
    v_mul_f32 v55, v158, v55
    v_mul_f32 v56, v158, v56
    v_mul_f32 v57, v158, v57
    v_mul_f32 v58, v158, v58
    v_mul_f32 v59, v158, v59
    v_mul_f32 v60, v158, v60
    v_mul_f32 v61, v158, v61
    v_mul_f32 v62, v158, v62
    v_mul_f32 v63, v158, v63
    v_cvt_pk_bf16_f32 v144, v112, v113
    v_cvt_pk_bf16_f32 v145, v114, v115
    v_cvt_pk_bf16_f32 v146, v116, v117
    v_cvt_pk_bf16_f32 v147, v118, v119
    v_cvt_pk_bf16_f32 v148, v120, v121
    v_cvt_pk_bf16_f32 v149, v122, v123
    v_cvt_pk_bf16_f32 v150, v124, v125
    v_cvt_pk_bf16_f32 v151, v126, v127
    v_mfma_f32_32x32x16_bf16 v[48:63], v[24:27], v[144:147], v[48:63]
    s_nop 0
    v_mfma_f32_32x32x16_bf16 v[48:63], v[28:31], v[148:151], v[48:63]
    v_mfma_f32_32x32x16_bf16 v[112:127], v[16:19], v[200:203], 0
    v_mfma_f32_32x32x16_bf16 v[112:127], v[20:23], v[204:207], v[112:127]
    s_nop 11
    v_max3_f32 v156, v112, v113, v114
    v_max3_f32 v156, v156, v115, v116
    v_max3_f32 v156, v156, v117, v118
    v_max_f32 v156, v156, v119
    v_max3_f32 v157, v120, v121, v122
    v_max3_f32 v157, v157, v123, v124
    v_max3_f32 v157, v157, v125, v126
    v_max_f32 v157, v157, v127
    v_max_f32 v156, v156, v157
    v_mov_b32 v157, v156
    s_nop 1
    v_permlane32_swap_b32 v156, v157
    v_max_f32 v156, v156, v157
    v_min_f32 v157, v153, -v156
    v_sub_f32 v158, v157, v153
    v_exp_f32 v158, v158
    v_mov_b32 v153, v157
    v_add_f32 v112, v112, v157
    v_add_f32 v113, v113, v157
    v_add_f32 v114, v114, v157
    v_add_f32 v115, v115, v157
    v_add_f32 v116, v116, v157
    v_add_f32 v117, v117, v157
    v_add_f32 v118, v118, v157
    v_add_f32 v119, v119, v157
    v_add_f32 v120, v120, v157
    v_add_f32 v121, v121, v157
    v_add_f32 v122, v122, v157
    v_add_f32 v123, v123, v157
    v_add_f32 v124, v124, v157
    v_add_f32 v125, v125, v157
    v_add_f32 v126, v126, v157
    v_add_f32 v127, v127, v157
    v_exp_f32 v112, v112
    v_exp_f32 v113, v113
    v_exp_f32 v114, v114
    v_exp_f32 v115, v115
    v_exp_f32 v116, v116
    v_exp_f32 v117, v117
    v_exp_f32 v118, v118
    v_exp_f32 v119, v119
    v_exp_f32 v120, v120
    v_exp_f32 v121, v121
    v_exp_f32 v122, v122
    v_exp_f32 v123, v123
    v_exp_f32 v124, v124
    v_exp_f32 v125, v125
    v_exp_f32 v126, v126
    v_exp_f32 v127, v127
    v_mul_f32 v64, v158, v64
    v_mul_f32 v65, v158, v65
    v_mul_f32 v66, v158, v66
    v_mul_f32 v67, v158, v67
    v_mul_f32 v68, v158, v68
    v_mul_f32 v69, v158, v69
    v_mul_f32 v70, v158, v70
    v_mul_f32 v71, v158, v71
    v_mul_f32 v72, v158, v72
    v_mul_f32 v73, v158, v73
    v_mul_f32 v74, v158, v74
    v_mul_f32 v75, v158, v75
    v_mul_f32 v76, v158, v76
    v_mul_f32 v77, v158, v77
    v_mul_f32 v78, v158, v78
    v_mul_f32 v79, v158, v79
    v_cvt_pk_bf16_f32 v144, v112, v113
    v_cvt_pk_bf16_f32 v145, v114, v115
    v_cvt_pk_bf16_f32 v146, v116, v117
    v_cvt_pk_bf16_f32 v147, v118, v119
    v_cvt_pk_bf16_f32 v148, v120, v121
    v_cvt_pk_bf16_f32 v149, v122, v123
    v_cvt_pk_bf16_f32 v150, v124, v125
    v_cvt_pk_bf16_f32 v151, v126, v127
    v_mfma_f32_32x32x16_bf16 v[64:79], v[24:27], v[144:147], v[64:79]
    s_nop 0
    v_mfma_f32_32x32x16_bf16 v[64:79], v[28:31], v[148:151], v[64:79]
    v_mfma_f32_32x32x16_bf16 v[112:127], v[16:19], v[208:211], 0
    v_mfma_f32_32x32x16_bf16 v[112:127], v[20:23], v[212:215], v[112:127]
    s_nop 11
    v_max3_f32 v156, v112, v113, v114
    v_max3_f32 v156, v156, v115, v116
    v_max3_f32 v156, v156, v117, v118
    v_max_f32 v156, v156, v119
    v_max3_f32 v157, v120, v121, v122
    v_max3_f32 v157, v157, v123, v124
    v_max3_f32 v157, v157, v125, v126
    v_max_f32 v157, v157, v127
    v_max_f32 v156, v156, v157
    v_mov_b32 v157, v156
    s_nop 1
    v_permlane32_swap_b32 v156, v157
    v_max_f32 v156, v156, v157
    v_min_f32 v157, v154, -v156
    v_sub_f32 v158, v157, v154
    v_exp_f32 v158, v158
    v_mov_b32 v154, v157
    v_add_f32 v112, v112, v157
    v_add_f32 v113, v113, v157
    v_add_f32 v114, v114, v157
    v_add_f32 v115, v115, v157
    v_add_f32 v116, v116, v157
    v_add_f32 v117, v117, v157
    v_add_f32 v118, v118, v157
    v_add_f32 v119, v119, v157
    v_add_f32 v120, v120, v157
    v_add_f32 v121, v121, v157
    v_add_f32 v122, v122, v157
    v_add_f32 v123, v123, v157
    v_add_f32 v124, v124, v157
    v_add_f32 v125, v125, v157
    v_add_f32 v126, v126, v157
    v_add_f32 v127, v127, v157
    v_exp_f32 v112, v112
    v_exp_f32 v113, v113
    v_exp_f32 v114, v114
    v_exp_f32 v115, v115
    v_exp_f32 v116, v116
    v_exp_f32 v117, v117
    v_exp_f32 v118, v118
    v_exp_f32 v119, v119
    v_exp_f32 v120, v120
    v_exp_f32 v121, v121
    v_exp_f32 v122, v122
    v_exp_f32 v123, v123
    v_exp_f32 v124, v124
    v_exp_f32 v125, v125
    v_exp_f32 v126, v126
    v_exp_f32 v127, v127
    v_mul_f32 v80, v158, v80
    v_mul_f32 v81, v158, v81
    v_mul_f32 v82, v158, v82
    v_mul_f32 v83, v158, v83
    v_mul_f32 v84, v158, v84
    v_mul_f32 v85, v158, v85
    v_mul_f32 v86, v158, v86
    v_mul_f32 v87, v158, v87
    v_mul_f32 v88, v158, v88
    v_mul_f32 v89, v158, v89
    v_mul_f32 v90, v158, v90
    v_mul_f32 v91, v158, v91
    v_mul_f32 v92, v158, v92
    v_mul_f32 v93, v158, v93
    v_mul_f32 v94, v158, v94
    v_mul_f32 v95, v158, v95
    v_cvt_pk_bf16_f32 v144, v112, v113
    v_cvt_pk_bf16_f32 v145, v114, v115
    v_cvt_pk_bf16_f32 v146, v116, v117
    v_cvt_pk_bf16_f32 v147, v118, v119
    v_cvt_pk_bf16_f32 v148, v120, v121
    v_cvt_pk_bf16_f32 v149, v122, v123
    v_cvt_pk_bf16_f32 v150, v124, v125
    v_cvt_pk_bf16_f32 v151, v126, v127
    v_mfma_f32_32x32x16_bf16 v[80:95], v[24:27], v[144:147], v[80:95]
    s_nop 0
    v_mfma_f32_32x32x16_bf16 v[80:95], v[28:31], v[148:151], v[80:95]
    v_mfma_f32_32x32x16_bf16 v[112:127], v[16:19], v[216:219], 0
    v_mfma_f32_32x32x16_bf16 v[112:127], v[20:23], v[220:223], v[112:127]
    s_nop 11
    v_max3_f32 v156, v112, v113, v114
    v_max3_f32 v156, v156, v115, v116
    v_max3_f32 v156, v156, v117, v118
    v_max_f32 v156, v156, v119
    v_max3_f32 v157, v120, v121, v122
    v_max3_f32 v157, v157, v123, v124
    v_max3_f32 v157, v157, v125, v126
    v_max_f32 v157, v157, v127
    v_max_f32 v156, v156, v157
    v_mov_b32 v157, v156
    s_nop 1
    v_permlane32_swap_b32 v156, v157
    v_max_f32 v156, v156, v157
    v_min_f32 v157, v155, -v156
    v_sub_f32 v158, v157, v155
    v_exp_f32 v158, v158
    v_mov_b32 v155, v157
    v_add_f32 v112, v112, v157
    v_add_f32 v113, v113, v157
    v_add_f32 v114, v114, v157
    v_add_f32 v115, v115, v157
    v_add_f32 v116, v116, v157
    v_add_f32 v117, v117, v157
    v_add_f32 v118, v118, v157
    v_add_f32 v119, v119, v157
    v_add_f32 v120, v120, v157
    v_add_f32 v121, v121, v157
    v_add_f32 v122, v122, v157
    v_add_f32 v123, v123, v157
    v_add_f32 v124, v124, v157
    v_add_f32 v125, v125, v157
    v_add_f32 v126, v126, v157
    v_add_f32 v127, v127, v157
    v_exp_f32 v112, v112
    v_exp_f32 v113, v113
    v_exp_f32 v114, v114
    v_exp_f32 v115, v115
    v_exp_f32 v116, v116
    v_exp_f32 v117, v117
    v_exp_f32 v118, v118
    v_exp_f32 v119, v119
    v_exp_f32 v120, v120
    v_exp_f32 v121, v121
    v_exp_f32 v122, v122
    v_exp_f32 v123, v123
    v_exp_f32 v124, v124
    v_exp_f32 v125, v125
    v_exp_f32 v126, v126
    v_exp_f32 v127, v127
    v_mul_f32 v96, v158, v96
    v_mul_f32 v97, v158, v97
    v_mul_f32 v98, v158, v98
    v_mul_f32 v99, v158, v99
    v_mul_f32 v100, v158, v100
    v_mul_f32 v101, v158, v101
    v_mul_f32 v102, v158, v102
    v_mul_f32 v103, v158, v103
    v_mul_f32 v104, v158, v104
    v_mul_f32 v105, v158, v105
    v_mul_f32 v106, v158, v106
    v_mul_f32 v107, v158, v107
    v_mul_f32 v108, v158, v108
    v_mul_f32 v109, v158, v109
    v_mul_f32 v110, v158, v110
    v_mul_f32 v111, v158, v111
    v_cvt_pk_bf16_f32 v144, v112, v113
    v_cvt_pk_bf16_f32 v145, v114, v115
    v_cvt_pk_bf16_f32 v146, v116, v117
    v_cvt_pk_bf16_f32 v147, v118, v119
    v_cvt_pk_bf16_f32 v148, v120, v121
    v_cvt_pk_bf16_f32 v149, v122, v123
    v_cvt_pk_bf16_f32 v150, v124, v125
    v_cvt_pk_bf16_f32 v151, v126, v127
    v_mfma_f32_32x32x16_bf16 v[96:111], v[24:27], v[144:147], v[96:111]
    s_nop 0
    v_mfma_f32_32x32x16_bf16 v[96:111], v[28:31], v[148:151], v[96:111]
    s_nop 15
    s_add_u32 s58, s58, 28672
    s_add_u32 s59, s59, 28672
    s_add_u32 s57, s57, 1
    s_cmp_lt_u32 s57, 16
    s_cbranch_scc1 FB_LOOP
    s_mov_b32 exec_lo, 0
    v_mov_b32 v61, v152
    s_mov_b32 exec_lo, -1
    ds_write_b128 v234, v[48:51] offset:0
    ds_write_b128 v234, v[52:55] offset:1024
    ds_write_b128 v234, v[56:59] offset:2048
    ds_write_b128 v234, v[60:63] offset:3072
    s_mov_b32 exec_lo, 0
    v_mov_b32 v77, v153
    s_mov_b32 exec_lo, -1
    ds_write_b128 v234, v[64:67] offset:4096
    ds_write_b128 v234, v[68:71] offset:5120
    ds_write_b128 v234, v[72:75] offset:6144
    ds_write_b128 v234, v[76:79] offset:7168
    s_mov_b32 exec_lo, 0
    v_mov_b32 v93, v154
    s_mov_b32 exec_lo, -1
    ds_write_b128 v234, v[80:83] offset:8192
    ds_write_b128 v234, v[84:87] offset:9216
    ds_write_b128 v234, v[88:91] offset:10240
    ds_write_b128 v234, v[92:95] offset:11264
    s_mov_b32 exec_lo, 0
    v_mov_b32 v109, v155
    s_mov_b32 exec_lo, -1
    ds_write_b128 v234, v[96:99] offset:12288
    ds_write_b128 v234, v[100:103] offset:13312
    ds_write_b128 v234, v[104:107] offset:14336
    ds_write_b128 v234, v[108:111] offset:15360
    s_branch COMBINE
K_END:
    s_endpgm
K_CODE_END:
.section .rodata,"a"
.p2align 6
.amdhsa_kernel gated_mix__mha_block__sliding_local_dilated__prompt_kernel
  .amdhsa_next_free_vgpr 256
  .amdhsa_next_free_sgpr 100
  .amdhsa_accum_offset 256
  .amdhsa_group_segment_fixed_size 0
  .amdhsa_kernarg_size 80
  .amdhsa_user_sgpr_count 2
  .amdhsa_user_sgpr_kernarg_segment_ptr 1
  .amdhsa_system_sgpr_workgroup_id_x 1
.end_amdhsa_kernel
```
